```python
import torch

def _softmax(x, axis=-1):
    return torch.softmax(x, dim=axis)
def _gelu(x):
    return torch.nn.functional.gelu(x, approximate="tanh")
def _silu(x):
    return torch.nn.functional.silu(x)
def _sigmoid(x):
    return torch.sigmoid(x)
def _layernorm(x, axis=-1, eps=1e-5):
    m = x.mean(dim=axis, keepdim=True)
    v = x.var(dim=axis, keepdim=True, unbiased=False)
    return (x - m) / torch.sqrt(v + eps)
def _scatter_add(tgt, idx, src, axis=0):
    return tgt.clone().index_add_(axis, idx, src)
def _segment_sum(src, seg, n):
    out = torch.zeros((n,) + src.shape[1:], dtype=src.dtype)
    return out.index_add_(0, seg, src)
def _pad(x, pw):
    flat = tuple(v for pair in reversed(pw) for v in pair)
    return torch.nn.functional.pad(x, flat)

kernel_name = 'concat_heads__sliding_block_cached__compressed_kv_cla__decode'

def setup_inputs():

    _w = (lambda a: (lambda t: t.to(torch.bfloat16) if t.is_floating_point() else t)(torch.as_tensor(a)))
    def _A_setup():
        B, Sq, D = 4, 1, 512
        Hq, Hkv, Sk, Dh = 32, 8, 8192, 128
        assert Hq % Hkv == 0, (Hq, Hkv)
        return {
            "x": _w((lambda *s: torch.randn(*s, dtype=torch.bfloat16) * 1.6)(B, Sq, D)),
            "k_cache": _w((lambda *s: torch.randn(*s, dtype=torch.bfloat16) * 1.6)(B, Hkv, Sk, Dh)),
            "v_cache": _w((lambda *s: torch.randn(*s, dtype=torch.bfloat16) * 0.05)(B, Hkv, Sk, Dh)),
            "wq": _w((lambda *s: torch.randn(*s, dtype=torch.bfloat16) * 1.6)(D, Hq * Dh) * (D ** -0.5)),
            "wo": _w((lambda *s: torch.randn(*s, dtype=torch.bfloat16) * 0.05)(Hq * Dh, D) * ((Hq * Dh) ** -0.5)),
        }
    _A_in = _A_setup()

    def _B_setup():
        B, H, Sq, Sk, D, M = 4, 32, 1, 8192, 128, 512
        Dc = 4 * D
        return {
            "x": _w((lambda *s: torch.randn(*s, dtype=torch.bfloat16) * 3.2)(B, Sq, M)),
            "c_kv": _w((lambda *s: torch.randn(*s, dtype=torch.bfloat16) * 0.1)(B, Sk, Dc)),
            "w_q": _w((lambda *s: torch.randn(*s, dtype=torch.bfloat16) * 6.4)(M, H, D) * (M ** -0.5)),
            "w_uk": _w((lambda *s: torch.randn(*s, dtype=torch.bfloat16) * 6.4)(Dc, H, D) * (Dc ** -0.5)),
            "w_uv": _w((lambda *s: torch.randn(*s, dtype=torch.bfloat16) * 0.1)(Dc, H, D) * (Dc ** -0.5)),
            "w_o": _w((lambda *s: torch.randn(*s, dtype=torch.bfloat16) * 0.1)(H, D, M) * ((H * D) ** -0.5)),
        }
    _B_in = _B_setup()

    return {
        "A_x": _A_in["x"],
        "A_k_cache": _A_in["k_cache"],
        "A_v_cache": _A_in["v_cache"],
        "A_wq": _A_in["wq"],
        "A_wo": _A_in["wo"],
        "B_x": _B_in["x"],
        "B_c_kv": _B_in["c_kv"],
        "B_w_q": _B_in["w_q"],
        "B_w_uk": _B_in["w_uk"],
        "B_w_uv": _B_in["w_uv"],
        "B_w_o": _B_in["w_o"],
    }

def reference(A_x, A_k_cache, A_v_cache, A_wq, A_wo, B_x, B_c_kv, B_w_q, B_w_uk, B_w_uv, B_w_o):
    def _A_ref(x, k_cache, v_cache, wq, wo):
        B, Sq, D = x.shape
        Hq, Dh = 32, 128
        Hkv, Sk = k_cache.shape[1], k_cache.shape[2]
        W = min(4096, max(256, Sk // 4))
        rep = Hq // Hkv
        q = (lambda x, *d: x.permute(*d))((x @ wq).reshape(B, Sq, Hq, Dh), 0, 2, 1, 3)
        k = (lambda x, n, axis: torch.repeat_interleave(x, n, dim=axis))(k_cache[:, :, Sk - W:, :], rep, axis=1)
        v = (lambda x, n, axis: torch.repeat_interleave(x, n, dim=axis))(v_cache[:, :, Sk - W:, :], rep, axis=1)
        scores = torch.einsum("bhqd,bhkd->bhqk", q, k) * (Dh ** -0.5)
        p = _softmax(scores, axis=-1)
        o = torch.einsum("bhqk,bhkd->bhqd", p, v)
        return (lambda x, *d: x.permute(*d))(o, 0, 2, 1, 3).reshape(B, Sq, Hq * Dh) @ wo

    def _B_ref(x, c_kv, w_q, w_uk, w_uv, w_o):
        B, Sq, M = x.shape[0], x.shape[1], x.shape[2]
        Sk = c_kv.shape[1]
        H, D = w_q.shape[1], w_q.shape[2]
        q = torch.einsum("bqm,mhd->bhqd", x, w_q)
        k = torch.einsum("bkc,chd->bhkd", c_kv, w_uk)
        v = torch.einsum("bkc,chd->bhkd", c_kv, w_uv)
        scores = torch.einsum("bhqd,bhkd->bhqk", q, k) * (D ** -0.5)
        off = Sk - Sq
        qi = torch.arange(Sq)[:, None]
        kj = torch.arange(Sk)[None, :]
        cmask = kj <= (qi + off)
        scores = torch.where(cmask[None, None], scores, -1e9)
        p = _softmax(scores, axis=-1)
        ctx = torch.einsum("bhqk,bhkd->bhqd", p, v)
        return torch.einsum("bhqd,hdm->bqm", ctx, w_o)

    a = _A_ref(A_x, A_k_cache, A_v_cache, A_wq, A_wo)
    b = _B_ref(B_x, B_c_kv, B_w_q, B_w_uk, B_w_uv, B_w_o)
    return torch.concatenate([a, b], axis=-1)
```

```asm
; @launch kernel=k12_q_kernel grid=(160,1,1) block=(256,1,1) lds=136192
; @launch kernel=k3_attn_kernel grid=(256,1,1) block=(512,1,1) lds=163840
; @launch kernel=k4_comb_kernel grid=(320,1,1) block=(256,1,1) lds=36864
; @launch kernel=k5_oproj_kernel grid=(128,1,1) block=(256,1,1) lds=36864
; @launch kernel=concat_heads__sliding_block_cached__compressed_kv_cla__decode_kernel grid=(16,1,1) block=(256,1,1) lds=0
.amdgcn_target "amdgcn-amd-amdhsa--gfx950"
.text
.globl k1_qproj_kernel
.p2align 8
.type k1_qproj_kernel,@function
k1_qproj_kernel:
    s_cmp_ge_u32 s2, 256
    s_cbranch_scc1 K1_END
    s_load_dwordx2 s[4:5], s[0:1], 0
    s_load_dwordx2 s[6:7], s[0:1], 24
    s_load_dwordx2 s[8:9], s[0:1], 40
    s_load_dwordx2 s[10:11], s[0:1], 56
    s_load_dwordx2 s[14:15], s[0:1], 104
    v_lshrrev_b32 v4, 6, v0
    v_and_b32 v1, 63, v0
    v_readfirstlane_b32 s18, v4
    v_and_b32 v2, 15, v1
    v_lshrrev_b32 v3, 4, v1
    s_lshr_b32 s19, s2, 7
    s_bfe_u32 s16, s2, 0x50002
    s_and_b32 s17, s2, 3
    s_cmp_eq_u32 s19, 1
    s_waitcnt lgkmcnt(0)
    s_cselect_b32 s20, s10, s6
    s_cselect_b32 s21, s11, s7
    s_mov_b32 s22, 0x400000
    s_mov_b32 s23, 0x00020000
    s_cselect_b32 s24, s8, s4
    s_cselect_b32 s25, s9, s5
    s_mov_b32 s26, 4096
    s_mov_b32 s27, 0x00020000
    s_mov_b32 s32, s14
    s_mov_b32 s33, s15
    s_mov_b32 s34, 0x10000000
    s_mov_b32 s35, 0x00020000
    v_add_u32 v7, 0, v3
    v_lshlrev_b32 v7, 1, v7
    v_xor_b32 v7, v7, v2
    v_lshlrev_b32 v7, 4, v7
    v_lshl_add_u32 v10, v3, 13, v7
    v_add_u32 v7, 4, v3
    v_lshlrev_b32 v7, 1, v7
    v_xor_b32 v7, v7, v2
    v_lshlrev_b32 v7, 4, v7
    v_lshl_add_u32 v11, v3, 13, v7
    s_lshl_b32 s36, s18, 13
    s_lshl_b32 s37, s18, 18
    s_lshl_b32 s38, s16, 8
    s_add_u32 s37, s37, s38
    s_lshl_b32 s38, s17, 20
    s_add_u32 s37, s37, s38
    s_mov_b32 m0, s36
    s_add_u32 s36, s36, 1024
    buffer_load_dwordx4 v10, s[20:23], s37 offen lds
    s_add_u32 s37, s37, 32768
    s_mov_b32 m0, s36
    s_add_u32 s36, s36, 1024
    buffer_load_dwordx4 v11, s[20:23], s37 offen lds
    s_add_u32 s37, s37, 32768
    s_mov_b32 m0, s36
    s_add_u32 s36, s36, 1024
    buffer_load_dwordx4 v10, s[20:23], s37 offen lds
    s_add_u32 s37, s37, 32768
    s_mov_b32 m0, s36
    s_add_u32 s36, s36, 1024
    buffer_load_dwordx4 v11, s[20:23], s37 offen lds
    s_add_u32 s37, s37, 32768
    s_mov_b32 m0, s36
    s_add_u32 s36, s36, 1024
    buffer_load_dwordx4 v10, s[20:23], s37 offen lds
    s_add_u32 s37, s37, 32768
    s_mov_b32 m0, s36
    s_add_u32 s36, s36, 1024
    buffer_load_dwordx4 v11, s[20:23], s37 offen lds
    s_add_u32 s37, s37, 32768
    s_mov_b32 m0, s36
    s_add_u32 s36, s36, 1024
    buffer_load_dwordx4 v10, s[20:23], s37 offen lds
    s_add_u32 s37, s37, 32768
    s_mov_b32 m0, s36
    s_add_u32 s36, s36, 1024
    buffer_load_dwordx4 v11, s[20:23], s37 offen lds
    s_add_u32 s37, s37, 32768
    v_and_b32 v4, 3, v1
    v_lshlrev_b32 v4, 10, v4
    v_lshl_add_u32 v4, v3, 4, v4
    s_lshl_b32 s36, s17, 8
    buffer_load_dwordx4 v[32:35], v4, s[24:27], s36 offen offset:0
    buffer_load_dwordx4 v[36:39], v4, s[24:27], s36 offen offset:64
    buffer_load_dwordx4 v[40:43], v4, s[24:27], s36 offen offset:128
    buffer_load_dwordx4 v[44:47], v4, s[24:27], s36 offen offset:192
    v_lshrrev_b32 v8, 2, v2
    v_lshlrev_b32 v9, 1, v8
    v_lshl_add_u32 v8, v3, 3, v8
    v_bfe_u32 v12, v2, 1, 1
    v_xor_b32 v9, v9, v12
    s_lshl_b32 s36, s18, 2
    v_xor_b32 v9, s36, v9
    v_lshlrev_b32 v9, 4, v9
    v_lshl_add_u32 v8, v8, 8, v9
    v_and_b32 v9, 1, v2
    v_lshl_add_u32 v8, v9, 3, v8
    v_xor_b32 v9, 32, v8
    v_xor_b32 v5, 128, v8
    v_add_u32 v5, 1024, v5
    v_xor_b32 v6, 32, v5
    s_waitcnt vmcnt(0)
    s_barrier
    ds_read_b64_tr_b16 v[48:49], v8 offset:0
    ds_read_b64_tr_b16 v[50:51], v5 offset:0
    ds_read_b64_tr_b16 v[52:53], v9 offset:0
    ds_read_b64_tr_b16 v[54:55], v6 offset:0
    ds_read_b64_tr_b16 v[56:57], v8 offset:8192
    ds_read_b64_tr_b16 v[58:59], v5 offset:8192
    ds_read_b64_tr_b16 v[60:61], v9 offset:8192
    ds_read_b64_tr_b16 v[62:63], v6 offset:8192
    ds_read_b64_tr_b16 v[64:65], v8 offset:16384
    ds_read_b64_tr_b16 v[66:67], v5 offset:16384
    ds_read_b64_tr_b16 v[68:69], v9 offset:16384
    ds_read_b64_tr_b16 v[70:71], v6 offset:16384
    ds_read_b64_tr_b16 v[72:73], v8 offset:24576
    ds_read_b64_tr_b16 v[74:75], v5 offset:24576
    ds_read_b64_tr_b16 v[76:77], v9 offset:24576
    ds_read_b64_tr_b16 v[78:79], v6 offset:24576
    s_waitcnt lgkmcnt(0)
    v_mfma_f32_16x16x32_bf16 v[24:27], v[48:51], v[32:35], 0
    v_mfma_f32_16x16x32_bf16 v[28:31], v[52:55], v[32:35], 0
    v_mfma_f32_16x16x32_bf16 v[24:27], v[56:59], v[36:39], v[24:27]
    v_mfma_f32_16x16x32_bf16 v[28:31], v[60:63], v[36:39], v[28:31]
    v_mfma_f32_16x16x32_bf16 v[24:27], v[64:67], v[40:43], v[24:27]
    v_mfma_f32_16x16x32_bf16 v[28:31], v[68:71], v[40:43], v[28:31]
    v_mfma_f32_16x16x32_bf16 v[24:27], v[72:75], v[44:47], v[24:27]
    v_mfma_f32_16x16x32_bf16 v[28:31], v[76:79], v[44:47], v[28:31]
    v_lshlrev_b32 v5, 14, v2
    v_lshl_add_u32 v5, v3, 4, v5
    s_lshl_b32 s36, s17, 17
    s_lshl_b32 s37, s19, 16
    s_add_u32 s36, s36, s37
    s_lshl_b32 s37, s16, 9
    s_add_u32 s36, s36, s37
    s_lshl_b32 s37, s18, 7
    s_add_u32 s36, s36, s37
    s_add_u32 s36, s36, 8388608
    v_cmp_gt_u32 vcc, 4, v2
    s_and_saveexec_b64 s[38:39], vcc
    buffer_store_dwordx4 v[24:27], v5, s[32:35], s36 offen
    buffer_store_dwordx4 v[28:31], v5, s[32:35], s36 offen offset:64
K1_END:
    s_endpgm
.section .rodata,"a"
.p2align 6
.amdhsa_kernel k1_qproj_kernel
  .amdhsa_next_free_vgpr 80
  .amdhsa_next_free_sgpr 96
  .amdhsa_accum_offset 80
  .amdhsa_group_segment_fixed_size 0
  .amdhsa_kernarg_size 112
  .amdhsa_user_sgpr_count 2
  .amdhsa_user_sgpr_kernarg_segment_ptr 1
  .amdhsa_system_sgpr_workgroup_id_x 1
.end_amdhsa_kernel
.text
.globl k2_qabs_kernel
.p2align 8
.type k2_qabs_kernel,@function
k2_qabs_kernel:
    s_cmp_ge_u32 s2, 144
    s_cbranch_scc1 K2_END
    s_load_dwordx2 s[4:5], s[0:1], 64
    s_load_dwordx2 s[6:7], s[0:1], 104
    v_lshrrev_b32 v4, 6, v0
    v_and_b32 v1, 63, v0
    v_readfirstlane_b32 s18, v4
    v_and_b32 v2, 15, v1
    v_lshrrev_b32 v3, 4, v1
    s_lshr_b32 s16, s2, 2
    s_and_b32 s17, s2, 3
    s_waitcnt lgkmcnt(0)
    s_mov_b32 s8, s4
    s_mov_b32 s9, s5
    s_mov_b32 s10, 0x400000
    s_mov_b32 s11, 0x00020000
    s_mov_b32 s12, s6
    s_mov_b32 s13, s7
    s_mov_b32 s14, 0x10000000
    s_mov_b32 s15, 0x00020000
    s_cmp_ge_u32 s2, 128
    s_cbranch_scc1 K2_A
    v_lshlrev_b32 v5, 13, v2
    v_lshl_add_u32 v5, v3, 4, v5
    s_lshl_b32 s20, s17, 20
    s_lshl_b32 s21, s18, 18
    s_add_u32 s20, s20, s21
    s_lshl_b32 s21, s16, 8
    s_add_u32 s20, s20, s21
    s_add_u32 s21, s20, 0x20000
    buffer_load_dwordx4 v[32:35], v5, s[8:11], s20 offen offset:0
    buffer_load_dwordx4 v[36:39], v5, s[8:11], s20 offen offset:64
    buffer_load_dwordx4 v[40:43], v5, s[8:11], s20 offen offset:128
    buffer_load_dwordx4 v[44:47], v5, s[8:11], s20 offen offset:192
    buffer_load_dwordx4 v[48:51], v5, s[8:11], s21 offen offset:0
    buffer_load_dwordx4 v[52:55], v5, s[8:11], s21 offen offset:64
    buffer_load_dwordx4 v[56:59], v5, s[8:11], s21 offen offset:128
    buffer_load_dwordx4 v[60:63], v5, s[8:11], s21 offen offset:192
    v_and_b32 v6, 3, v1
    v_lshlrev_b32 v6, 14, v6
    v_lshl_add_u32 v6, v3, 5, v6
    s_lshl_b32 s22, s16, 9
    s_add_u32 s22, s22, 8454144
    buffer_load_dwordx4 v[64:67], v6, s[12:15], s22 offen offset:0
    buffer_load_dwordx4 v[68:71], v6, s[12:15], s22 offen offset:16
    buffer_load_dwordx4 v[72:75], v6, s[12:15], s22 offen offset:128
    buffer_load_dwordx4 v[76:79], v6, s[12:15], s22 offen offset:144
    buffer_load_dwordx4 v[80:83], v6, s[12:15], s22 offen offset:256
    buffer_load_dwordx4 v[84:87], v6, s[12:15], s22 offen offset:272
    buffer_load_dwordx4 v[88:91], v6, s[12:15], s22 offen offset:384
    buffer_load_dwordx4 v[92:95], v6, s[12:15], s22 offen offset:400
    s_add_u32 s22, s22, 131072
    buffer_load_dwordx4 v[96:99], v6, s[12:15], s22 offen offset:0
    buffer_load_dwordx4 v[100:103], v6, s[12:15], s22 offen offset:16
    buffer_load_dwordx4 v[104:107], v6, s[12:15], s22 offen offset:128
    buffer_load_dwordx4 v[108:111], v6, s[12:15], s22 offen offset:144
    buffer_load_dwordx4 v[112:115], v6, s[12:15], s22 offen offset:256
    buffer_load_dwordx4 v[116:119], v6, s[12:15], s22 offen offset:272
    buffer_load_dwordx4 v[120:123], v6, s[12:15], s22 offen offset:384
    buffer_load_dwordx4 v[124:127], v6, s[12:15], s22 offen offset:400
    s_add_u32 s22, s22, 131072
    buffer_load_dwordx4 v[128:131], v6, s[12:15], s22 offen offset:0
    buffer_load_dwordx4 v[132:135], v6, s[12:15], s22 offen offset:16
    buffer_load_dwordx4 v[136:139], v6, s[12:15], s22 offen offset:128
    buffer_load_dwordx4 v[140:143], v6, s[12:15], s22 offen offset:144
    buffer_load_dwordx4 v[144:147], v6, s[12:15], s22 offen offset:256
    buffer_load_dwordx4 v[148:151], v6, s[12:15], s22 offen offset:272
    buffer_load_dwordx4 v[152:155], v6, s[12:15], s22 offen offset:384
    buffer_load_dwordx4 v[156:159], v6, s[12:15], s22 offen offset:400
    s_add_u32 s22, s22, 131072
    buffer_load_dwordx4 v[160:163], v6, s[12:15], s22 offen offset:0
    buffer_load_dwordx4 v[164:167], v6, s[12:15], s22 offen offset:16
    buffer_load_dwordx4 v[168:171], v6, s[12:15], s22 offen offset:128
    buffer_load_dwordx4 v[172:175], v6, s[12:15], s22 offen offset:144
    buffer_load_dwordx4 v[176:179], v6, s[12:15], s22 offen offset:256
    buffer_load_dwordx4 v[180:183], v6, s[12:15], s22 offen offset:272
    buffer_load_dwordx4 v[184:187], v6, s[12:15], s22 offen offset:384
    buffer_load_dwordx4 v[188:191], v6, s[12:15], s22 offen offset:400
    s_waitcnt vmcnt(0)
    v_pk_add_f32 v[64:65], v[64:65], v[96:97]
    v_pk_add_f32 v[128:129], v[128:129], v[160:161]
    v_pk_add_f32 v[64:65], v[64:65], v[128:129]
    v_cvt_pk_bf16_f32 v96, v64, v65
    v_pk_add_f32 v[66:67], v[66:67], v[98:99]
    v_pk_add_f32 v[130:131], v[130:131], v[162:163]
    v_pk_add_f32 v[66:67], v[66:67], v[130:131]
    v_cvt_pk_bf16_f32 v97, v66, v67
    v_pk_add_f32 v[68:69], v[68:69], v[100:101]
    v_pk_add_f32 v[132:133], v[132:133], v[164:165]
    v_pk_add_f32 v[68:69], v[68:69], v[132:133]
    v_cvt_pk_bf16_f32 v98, v68, v69
    v_pk_add_f32 v[70:71], v[70:71], v[102:103]
    v_pk_add_f32 v[134:135], v[134:135], v[166:167]
    v_pk_add_f32 v[70:71], v[70:71], v[134:135]
    v_cvt_pk_bf16_f32 v99, v70, v71
    v_pk_add_f32 v[72:73], v[72:73], v[104:105]
    v_pk_add_f32 v[136:137], v[136:137], v[168:169]
    v_pk_add_f32 v[72:73], v[72:73], v[136:137]
    v_cvt_pk_bf16_f32 v100, v72, v73
    v_pk_add_f32 v[74:75], v[74:75], v[106:107]
    v_pk_add_f32 v[138:139], v[138:139], v[170:171]
    v_pk_add_f32 v[74:75], v[74:75], v[138:139]
    v_cvt_pk_bf16_f32 v101, v74, v75
    v_pk_add_f32 v[76:77], v[76:77], v[108:109]
    v_pk_add_f32 v[140:141], v[140:141], v[172:173]
    v_pk_add_f32 v[76:77], v[76:77], v[140:141]
    v_cvt_pk_bf16_f32 v102, v76, v77
    v_pk_add_f32 v[78:79], v[78:79], v[110:111]
    v_pk_add_f32 v[142:143], v[142:143], v[174:175]
    v_pk_add_f32 v[78:79], v[78:79], v[142:143]
    v_cvt_pk_bf16_f32 v103, v78, v79
    v_pk_add_f32 v[80:81], v[80:81], v[112:113]
    v_pk_add_f32 v[144:145], v[144:145], v[176:177]
    v_pk_add_f32 v[80:81], v[80:81], v[144:145]
    v_cvt_pk_bf16_f32 v104, v80, v81
    v_pk_add_f32 v[82:83], v[82:83], v[114:115]
    v_pk_add_f32 v[146:147], v[146:147], v[178:179]
    v_pk_add_f32 v[82:83], v[82:83], v[146:147]
    v_cvt_pk_bf16_f32 v105, v82, v83
    v_pk_add_f32 v[84:85], v[84:85], v[116:117]
    v_pk_add_f32 v[148:149], v[148:149], v[180:181]
    v_pk_add_f32 v[84:85], v[84:85], v[148:149]
    v_cvt_pk_bf16_f32 v106, v84, v85
    v_pk_add_f32 v[86:87], v[86:87], v[118:119]
    v_pk_add_f32 v[150:151], v[150:151], v[182:183]
    v_pk_add_f32 v[86:87], v[86:87], v[150:151]
    v_cvt_pk_bf16_f32 v107, v86, v87
    v_pk_add_f32 v[88:89], v[88:89], v[120:121]
    v_pk_add_f32 v[152:153], v[152:153], v[184:185]
    v_pk_add_f32 v[88:89], v[88:89], v[152:153]
    v_cvt_pk_bf16_f32 v108, v88, v89
    v_pk_add_f32 v[90:91], v[90:91], v[122:123]
    v_pk_add_f32 v[154:155], v[154:155], v[186:187]
    v_pk_add_f32 v[90:91], v[90:91], v[154:155]
    v_cvt_pk_bf16_f32 v109, v90, v91
    v_pk_add_f32 v[92:93], v[92:93], v[124:125]
    v_pk_add_f32 v[156:157], v[156:157], v[188:189]
    v_pk_add_f32 v[92:93], v[92:93], v[156:157]
    v_cvt_pk_bf16_f32 v110, v92, v93
    v_pk_add_f32 v[94:95], v[94:95], v[126:127]
    v_pk_add_f32 v[158:159], v[158:159], v[190:191]
    v_pk_add_f32 v[94:95], v[94:95], v[158:159]
    v_cvt_pk_bf16_f32 v111, v94, v95
    s_nop 1
    v_mfma_f32_16x16x32_bf16 v[24:27], v[32:35], v[96:99], 0
    v_mfma_f32_16x16x32_bf16 v[24:27], v[36:39], v[100:103], v[24:27]
    v_mfma_f32_16x16x32_bf16 v[24:27], v[40:43], v[104:107], v[24:27]
    v_mfma_f32_16x16x32_bf16 v[24:27], v[44:47], v[108:111], v[24:27]
    v_mfma_f32_16x16x32_bf16 v[28:31], v[48:51], v[96:99], 0
    v_mfma_f32_16x16x32_bf16 v[28:31], v[52:55], v[100:103], v[28:31]
    v_mfma_f32_16x16x32_bf16 v[28:31], v[56:59], v[104:107], v[28:31]
    v_mfma_f32_16x16x32_bf16 v[28:31], v[60:63], v[108:111], v[28:31]
    s_mov_b32 s23, 0x3e0293ee
    v_lshlrev_b32 v5, 15, v2
    v_lshrrev_b32 v6, 1, v3
    v_lshl_add_u32 v5, v6, 9, v5
    v_and_b32 v6, 1, v3
    v_lshl_add_u32 v5, v6, 3, v5
    s_lshl_b32 s24, s17, 13
    s_lshl_b32 s25, s18, 11
    s_add_u32 s24, s24, s25
    s_lshl_b32 s25, s16, 4
    s_add_u32 s24, s24, s25
    s_add_u32 s24, s24, 65536
    v_mul_f32 v24, s23, v24
    v_mul_f32 v25, s23, v25
    v_mul_f32 v26, s23, v26
    v_mul_f32 v27, s23, v27
    v_cvt_pk_bf16_f32 v16, v24, v25
    v_cvt_pk_bf16_f32 v17, v26, v27
    v_mul_f32 v28, s23, v28
    v_mul_f32 v29, s23, v29
    v_mul_f32 v30, s23, v30
    v_mul_f32 v31, s23, v31
    v_cvt_pk_bf16_f32 v18, v28, v29
    v_cvt_pk_bf16_f32 v19, v30, v31
    v_cmp_gt_u32 vcc, 4, v2
    s_and_saveexec_b64 s[26:27], vcc
    buffer_store_dwordx2 v[16:17], v5, s[12:15], s24 offen
    buffer_store_dwordx2 v[18:19], v5, s[12:15], s24 offen offset:1024
    s_endpgm
K2_A:
    s_sub_u32 s16, s2, 128
    s_lshl_b32 s16, s16, 12
    v_lshl_add_u32 v5, v0, 4, s16
    s_mov_b32 s22, 8388608
    buffer_load_dwordx4 v[16:19], v5, s[12:15], s22 offen
    s_add_u32 s22, s22, 131072
    buffer_load_dwordx4 v[20:23], v5, s[12:15], s22 offen
    s_add_u32 s22, s22, 131072
    buffer_load_dwordx4 v[24:27], v5, s[12:15], s22 offen
    s_add_u32 s22, s22, 131072
    buffer_load_dwordx4 v[28:31], v5, s[12:15], s22 offen
    s_waitcnt vmcnt(0)
    v_pk_add_f32 v[16:17], v[16:17], v[20:21]
    v_pk_add_f32 v[24:25], v[24:25], v[28:29]
    v_pk_add_f32 v[16:17], v[16:17], v[24:25]
    v_cvt_pk_bf16_f32 v8, v16, v17
    v_pk_add_f32 v[18:19], v[18:19], v[22:23]
    v_pk_add_f32 v[26:27], v[26:27], v[30:31]
    v_pk_add_f32 v[18:19], v[18:19], v[26:27]
    v_cvt_pk_bf16_f32 v9, v18, v19
    v_lshrrev_b32 v5, 1, v5
    s_mov_b32 s22, 0
    buffer_store_dwordx2 v[8:9], v5, s[12:15], s22 offen
K2_END:
    s_endpgm
.section .rodata,"a"
.p2align 6
.amdhsa_kernel k2_qabs_kernel
  .amdhsa_next_free_vgpr 192
  .amdhsa_next_free_sgpr 96
  .amdhsa_accum_offset 192
  .amdhsa_group_segment_fixed_size 0
  .amdhsa_kernarg_size 112
  .amdhsa_user_sgpr_count 2
  .amdhsa_user_sgpr_kernarg_segment_ptr 1
  .amdhsa_system_sgpr_workgroup_id_x 1
.end_amdhsa_kernel
.text
.globl k12_q_kernel
.p2align 8
.type k12_q_kernel,@function
k12_q_kernel:
    s_cmp_ge_u32 s2, 160
    s_cbranch_scc1 K12_END
    s_load_dwordx2 s[4:5], s[0:1], 0
    s_load_dwordx2 s[6:7], s[0:1], 24
    s_load_dwordx2 s[8:9], s[0:1], 40
    s_load_dwordx2 s[10:11], s[0:1], 56
    s_load_dwordx2 s[12:13], s[0:1], 64
    s_load_dwordx2 s[14:15], s[0:1], 104
    v_lshrrev_b32 v4, 6, v0
    v_and_b32 v1, 63, v0
    v_readfirstlane_b32 s18, v4
    v_and_b32 v2, 15, v1
    v_lshrrev_b32 v3, 4, v1
    s_lshr_b32 s16, s2, 2
    s_and_b32 s17, s2, 3
    s_sub_u32 s19, s2, 128
    s_cmp_lt_u32 s2, 128
    s_cselect_b32 s16, s16, s19
    s_waitcnt lgkmcnt(0)
    s_cselect_b32 s20, s10, s6
    s_cselect_b32 s21, s11, s7
    s_mov_b32 s22, 0x400000
    s_mov_b32 s23, 0x00020000
    s_cselect_b32 s24, s8, s4
    s_cselect_b32 s25, s9, s5
    s_mov_b32 s26, 4096
    s_mov_b32 s27, 0x00020000
    s_mov_b32 s28, s12
    s_mov_b32 s29, s13
    s_mov_b32 s30, 0x400000
    s_mov_b32 s31, 0x00020000
    s_mov_b32 s32, s14
    s_mov_b32 s33, s15
    s_mov_b32 s34, 0x10000000
    s_mov_b32 s35, 0x00020000
    v_lshlrev_b32 v4, 4, v1
    s_lshl_b32 s36, s18, 10
    s_add_u32 s37, s36, 131072
    s_mov_b32 m0, s37
    s_nop 0
    buffer_load_dwordx4 v4, s[24:27], s36 offen lds
    v_add_u32 v7, 0, v3
    v_lshlrev_b32 v7, 1, v7
    v_xor_b32 v7, v7, v2
    v_lshlrev_b32 v7, 4, v7
    v_lshl_add_u32 v10, v3, 13, v7
    v_add_u32 v7, 4, v3
    v_lshlrev_b32 v7, 1, v7
    v_xor_b32 v7, v7, v2
    v_lshlrev_b32 v7, 4, v7
    v_lshl_add_u32 v11, v3, 13, v7
    s_lshl_b32 s36, s18, 15
    s_lshl_b32 s37, s18, 20
    s_lshl_b32 s38, s16, 8
    s_add_u32 s37, s37, s38
    s_mov_b32 s38, 0
K12_DMA:
    s_mov_b32 m0, s36
    s_add_u32 s36, s36, 1024
    buffer_load_dwordx4 v10, s[20:23], s37 offen lds
    s_add_u32 s37, s37, 32768
    s_mov_b32 m0, s36
    s_add_u32 s36, s36, 1024
    buffer_load_dwordx4 v11, s[20:23], s37 offen lds
    s_add_u32 s37, s37, 32768
    s_add_u32 s38, s38, 1
    s_cmp_lt_u32 s38, 16
    s_cbranch_scc1 K12_DMA
    s_cmp_lt_u32 s2, 128
    s_cbranch_scc0 K12_NOUK
    v_lshlrev_b32 v5, 13, v2
    v_lshl_add_u32 v5, v3, 4, v5
    s_lshl_b32 s36, s17, 20
    s_lshl_b32 s37, s18, 18
    s_add_u32 s36, s36, s37
    s_lshl_b32 s37, s16, 8
    s_add_u32 s36, s36, s37
    s_add_u32 s37, s36, 0x20000
    buffer_load_dwordx4 v[32:35], v5, s[28:31], s36 offen offset:0
    buffer_load_dwordx4 v[36:39], v5, s[28:31], s36 offen offset:64
    buffer_load_dwordx4 v[40:43], v5, s[28:31], s36 offen offset:128
    buffer_load_dwordx4 v[44:47], v5, s[28:31], s36 offen offset:192
    buffer_load_dwordx4 v[48:51], v5, s[28:31], s37 offen offset:0
    buffer_load_dwordx4 v[52:55], v5, s[28:31], s37 offen offset:64
    buffer_load_dwordx4 v[56:59], v5, s[28:31], s37 offen offset:128
    buffer_load_dwordx4 v[60:63], v5, s[28:31], s37 offen offset:192
K12_NOUK:
    v_and_b32 v4, 3, v1
    v_lshlrev_b32 v4, 10, v4
    v_lshl_add_u32 v4, v3, 4, v4
    v_add_u32 v4, 131072, v4
    v_lshrrev_b32 v8, 2, v2
    v_lshlrev_b32 v9, 1, v8
    v_lshl_add_u32 v8, v3, 3, v8
    v_bfe_u32 v12, v2, 1, 1
    v_xor_b32 v9, v9, v12
    s_lshl_b32 s36, s18, 2
    v_xor_b32 v9, s36, v9
    v_lshlrev_b32 v9, 4, v9
    v_lshl_add_u32 v8, v8, 8, v9
    v_and_b32 v9, 1, v2
    v_lshl_add_u32 v8, v9, 3, v8
    v_xor_b32 v9, 32, v8
    v_xor_b32 v5, 128, v8
    v_add_u32 v5, 1024, v5
    v_xor_b32 v6, 32, v5
    v_mov_b64 v[24:25], 0
    v_mov_b64 v[26:27], 0
    v_mov_b64 v[28:29], 0
    v_mov_b64 v[30:31], 0
    s_mov_b32 s38, 0
    s_waitcnt vmcnt(0)
    s_barrier
K12_MM:
    ds_read_b128 v[12:15], v4
    ds_read_b64_tr_b16 v[16:17], v8
    ds_read_b64_tr_b16 v[18:19], v5
    ds_read_b64_tr_b16 v[20:21], v9
    ds_read_b64_tr_b16 v[22:23], v6
    v_add_u32 v4, 64, v4
    v_add_u32 v8, 0x2000, v8
    v_add_u32 v9, 0x2000, v9
    v_add_u32 v5, 0x2000, v5
    v_add_u32 v6, 0x2000, v6
    s_add_u32 s38, s38, 1
    s_cmp_lt_u32 s38, 16
    s_waitcnt lgkmcnt(0)
    v_mfma_f32_16x16x32_bf16 v[24:27], v[16:19], v[12:15], v[24:27]
    v_mfma_f32_16x16x32_bf16 v[28:31], v[20:23], v[12:15], v[28:31]
    s_cbranch_scc1 K12_MM
    s_nop 7
    v_cvt_pk_bf16_f32 v16, v24, v25
    v_cvt_pk_bf16_f32 v17, v26, v27
    v_cvt_pk_bf16_f32 v18, v28, v29
    v_cvt_pk_bf16_f32 v19, v30, v31
    v_cmp_gt_u32 vcc, 4, v2
    s_cmp_lt_u32 s2, 128
    s_cbranch_scc1 K12_B2
    v_lshlrev_b32 v5, 13, v2
    v_lshl_add_u32 v5, v3, 3, v5
    s_lshl_b32 s36, s16, 8
    s_lshl_b32 s37, s18, 6
    s_add_u32 s36, s36, s37
    s_and_saveexec_b64 s[38:39], vcc
    buffer_store_dwordx2 v[16:17], v5, s[32:35], s36 offen offset:0
    buffer_store_dwordx2 v[18:19], v5, s[32:35], s36 offen offset:32
    s_endpgm
K12_B2:
    v_lshlrev_b32 v5, 8, v2
    v_lshl_add_u32 v5, v3, 3, v5
    s_lshl_b32 s37, s18, 6
    s_add_u32 s37, s37, 135168
    v_add_u32 v5, s37, v5
    s_and_saveexec_b64 s[38:39], vcc
    ds_write_b64 v5, v[16:17]
    ds_write_b64 v5, v[18:19] offset:32
    s_mov_b64 exec, s[38:39]
    v_and_b32 v4, 3, v1
    v_lshlrev_b32 v4, 8, v4
    v_lshl_add_u32 v4, v3, 4, v4
    v_add_u32 v4, 135168, v4
    s_waitcnt lgkmcnt(0)
    s_barrier
    ds_read_b128 v[64:67], v4 offset:0
    ds_read_b128 v[68:71], v4 offset:64
    ds_read_b128 v[72:75], v4 offset:128
    ds_read_b128 v[76:79], v4 offset:192
    s_waitcnt lgkmcnt(0)
    v_mfma_f32_16x16x32_bf16 v[24:27], v[32:35], v[64:67], 0
    v_mfma_f32_16x16x32_bf16 v[24:27], v[36:39], v[68:71], v[24:27]
    v_mfma_f32_16x16x32_bf16 v[24:27], v[40:43], v[72:75], v[24:27]
    v_mfma_f32_16x16x32_bf16 v[24:27], v[44:47], v[76:79], v[24:27]
    v_mfma_f32_16x16x32_bf16 v[28:31], v[48:51], v[64:67], 0
    v_mfma_f32_16x16x32_bf16 v[28:31], v[52:55], v[68:71], v[28:31]
    v_mfma_f32_16x16x32_bf16 v[28:31], v[56:59], v[72:75], v[28:31]
    v_mfma_f32_16x16x32_bf16 v[28:31], v[60:63], v[76:79], v[28:31]
    s_mov_b32 s36, 0x3e0293ee
    v_lshlrev_b32 v5, 15, v2
    v_lshrrev_b32 v6, 1, v3
    v_lshl_add_u32 v5, v6, 9, v5
    v_and_b32 v6, 1, v3
    v_lshl_add_u32 v5, v6, 3, v5
    s_lshl_b32 s24, s17, 13
    s_lshl_b32 s25, s18, 11
    s_add_u32 s24, s24, s25
    s_lshl_b32 s25, s16, 4
    s_add_u32 s24, s24, s25
    s_add_u32 s24, s24, 65536
    v_mul_f32 v24, s36, v24
    v_mul_f32 v25, s36, v25
    v_mul_f32 v26, s36, v26
    v_mul_f32 v27, s36, v27
    v_cvt_pk_bf16_f32 v16, v24, v25
    v_cvt_pk_bf16_f32 v17, v26, v27
    v_mul_f32 v28, s36, v28
    v_mul_f32 v29, s36, v29
    v_mul_f32 v30, s36, v30
    v_mul_f32 v31, s36, v31
    v_cvt_pk_bf16_f32 v18, v28, v29
    v_cvt_pk_bf16_f32 v19, v30, v31
    s_and_saveexec_b64 s[38:39], vcc
    buffer_store_dwordx2 v[16:17], v5, s[32:35], s24 offen
    buffer_store_dwordx2 v[18:19], v5, s[32:35], s24 offen offset:1024
K12_END:
    s_endpgm
.section .rodata,"a"
.p2align 6
.amdhsa_kernel k12_q_kernel
  .amdhsa_next_free_vgpr 80
  .amdhsa_next_free_sgpr 96
  .amdhsa_accum_offset 80
  .amdhsa_group_segment_fixed_size 0
  .amdhsa_kernarg_size 112
  .amdhsa_user_sgpr_count 2
  .amdhsa_user_sgpr_kernarg_segment_ptr 1
  .amdhsa_system_sgpr_workgroup_id_x 1
.end_amdhsa_kernel
.text
.globl k3_attn_kernel
.p2align 8
.type k3_attn_kernel,@function
k3_attn_kernel:
    s_cmp_ge_u32 s2, 256
    s_cbranch_scc1 K3_END
    s_cmp_ge_u32 s2, 128
    s_cbranch_scc1 K3_A
    s_load_dwordx2 s[4:5], s[0:1], 48
    s_load_dwordx2 s[6:7], s[0:1], 104
    v_lshrrev_b32 v4, 6, v0
    v_and_b32 v1, 63, v0
    v_readfirstlane_b32 s29, v4
    s_lshr_b32 s16, s2, 5
    s_and_b32 s17, s2, 31
    v_and_b32 v2, 31, v1
    v_lshrrev_b32 v3, 5, v1
    s_and_b32 s18, s29, 3
    s_lshr_b32 s30, s29, 2
    s_waitcnt lgkmcnt(0)
    s_mov_b32 s8, s4
    s_mov_b32 s9, s5
    s_mov_b32 s10, 0x2000000
    s_mov_b32 s11, 0x00020000
    s_mov_b32 s12, s6
    s_mov_b32 s13, s7
    s_mov_b32 s14, 0x10000000
    s_mov_b32 s15, 0x00020000
    v_lshlrev_b32 v4, 4, v1
    s_lshl_b32 s20, s16, 15
    s_lshl_b32 s21, s18, 13
    s_add_u32 s20, s20, s21
    s_add_u32 s20, s20, 65536
    buffer_load_dwordx4 v[32:35], v4, s[12:15], s20 offen offset:0
    buffer_load_dwordx4 v[36:39], v4, s[12:15], s20 offen offset:1024
    buffer_load_dwordx4 v[40:43], v4, s[12:15], s20 offen offset:2048
    buffer_load_dwordx4 v[44:47], v4, s[12:15], s20 offen offset:3072
    s_add_u32 s21, s20, 4096
    buffer_load_dwordx4 v[48:51], v4, s[12:15], s21 offen offset:0
    buffer_load_dwordx4 v[52:55], v4, s[12:15], s21 offen offset:1024
    buffer_load_dwordx4 v[56:59], v4, s[12:15], s21 offen offset:2048
    buffer_load_dwordx4 v[60:63], v4, s[12:15], s21 offen offset:3072
    v_lshrrev_b32 v4, 4, v1
    v_and_b32 v5, 15, v1
    v_lshlrev_b32 v6, 2, v4
    v_xor_b32 v5, v5, v6
    v_lshlrev_b32 v6, 10, v4
    v_xor_b32 v7, 0, v5
    v_lshl_add_u32 v8, v7, 4, v6
    v_xor_b32 v7, 1, v5
    v_lshl_add_u32 v9, v7, 4, v6
    v_xor_b32 v7, 2, v5
    v_lshl_add_u32 v10, v7, 4, v6
    v_xor_b32 v7, 3, v5
    v_lshl_add_u32 v11, v7, 4, v6
    s_lshl_b32 s19, s16, 23
    s_lshl_b32 s21, s17, 15
    s_add_u32 s19, s19, s21
    s_lshl_b32 s21, s18, 8
    s_add_u32 s19, s19, s21
    s_lshl_b32 s21, s30, 20
    s_add_u32 s19, s19, s21
    s_lshl_b32 s22, s30, 3
    s_add_u32 s22, s22, s18
    s_lshl_b32 s22, s22, 13
    s_mov_b32 s23, s22
    s_mov_b32 s24, s19
    s_mov_b32 s26, 0
K3_BPRO:
    s_mov_b32 m0, s23
    s_add_u32 s23, s23, 1024
    buffer_load_dwordx4 v8, s[8:11], s24 offen nt lds
    s_add_u32 s24, s24, 4096
    s_mov_b32 m0, s23
    s_add_u32 s23, s23, 1024
    buffer_load_dwordx4 v9, s[8:11], s24 offen nt lds
    s_add_u32 s24, s24, 4096
    s_mov_b32 m0, s23
    s_add_u32 s23, s23, 1024
    buffer_load_dwordx4 v10, s[8:11], s24 offen nt lds
    s_add_u32 s24, s24, 4096
    s_mov_b32 m0, s23
    s_add_u32 s23, s23, 1024
    buffer_load_dwordx4 v11, s[8:11], s24 offen nt lds
    s_add_u32 s24, s24, 4096
    s_mov_b32 m0, s23
    s_add_u32 s23, s23, 1024
    buffer_load_dwordx4 v8, s[8:11], s24 offen nt lds
    s_add_u32 s24, s24, 4096
    s_mov_b32 m0, s23
    s_add_u32 s23, s23, 1024
    buffer_load_dwordx4 v9, s[8:11], s24 offen nt lds
    s_add_u32 s24, s24, 4096
    s_mov_b32 m0, s23
    s_add_u32 s23, s23, 1024
    buffer_load_dwordx4 v10, s[8:11], s24 offen nt lds
    s_add_u32 s24, s24, 4096
    s_mov_b32 m0, s23
    s_add_u32 s23, s23, 1024
    buffer_load_dwordx4 v11, s[8:11], s24 offen nt lds
    s_add_u32 s24, s24, 4096
    s_add_u32 s23, s23, 24576
    s_add_u32 s24, s24, 0x1f8000
    s_add_u32 s26, s26, 1
    s_cmp_lt_u32 s26, 2
    s_cbranch_scc1 K3_BPRO
    v_and_b32 v4, 3, v2
    v_lshlrev_b32 v4, 2, v4
    v_bfe_u32 v5, v2, 2, 2
    v_or_b32 v4, v4, v5
    v_xor_b32 v4, v4, v3
    v_lshlrev_b32 v4, 4, v4
    v_lshl_add_u32 v4, v2, 8, v4
    v_add_u32 v4, s22, v4
    v_xor_b32 v12, 0, v4
    v_xor_b32 v13, 32, v4
    v_xor_b32 v14, 64, v4
    v_xor_b32 v15, 96, v4
    v_xor_b32 v16, 128, v4
    v_xor_b32 v17, 160, v4
    v_xor_b32 v18, 192, v4
    v_xor_b32 v19, 224, v4
    v_and_b32 v4, 15, v1
    v_lshrrev_b32 v5, 2, v4
    v_bfe_u32 v6, v1, 4, 1
    v_lshlrev_b32 v6, 1, v6
    v_bfe_u32 v7, v4, 1, 1
    v_add_u32 v6, v6, v7
    v_lshlrev_b32 v7, 2, v5
    v_or_b32 v7, v7, v3
    v_xor_b32 v6, v6, v7
    v_lshlrev_b32 v6, 4, v6
    v_lshlrev_b32 v7, 2, v3
    v_add_u32 v7, v7, v5
    v_lshl_add_u32 v6, v7, 8, v6
    v_and_b32 v7, 1, v4
    v_lshl_add_u32 v6, v7, 3, v6
    v_add_u32 v6, s22, v6
    v_xor_b32 v20, 0, v6
    v_xor_b32 v21, 32, v6
    v_add_u32 v21, 2048, v21
    v_xor_b32 v22, 64, v6
    v_xor_b32 v23, 96, v6
    v_add_u32 v23, 2048, v23
    v_xor_b32 v24, 128, v6
    v_xor_b32 v25, 160, v6
    v_add_u32 v25, 2048, v25
    v_xor_b32 v26, 192, v6
    v_xor_b32 v27, 224, v6
    v_add_u32 v27, 2048, v27
    s_lshl_b32 s25, s30, 14
    s_add_u32 s25, s25, 131072
    v_lshl_add_u32 v28, v1, 4, s25
    s_lshl_b32 s25, s18, 12
    v_add_u32 v4, s25, v28
    v_mov_b32 v29, 0xff7fffff
    v_mov_b32 v174, 0
    v_mov_b64 v[176:177], 0
    v_mov_b64 v[178:179], 0
    v_mov_b64 v[180:181], 0
    v_mov_b64 v[182:183], 0
    v_mov_b64 v[184:185], 0
    v_mov_b64 v[186:187], 0
    v_mov_b64 v[188:189], 0
    v_mov_b64 v[190:191], 0
    v_mov_b64 v[192:193], 0
    v_mov_b64 v[194:195], 0
    v_mov_b64 v[196:197], 0
    v_mov_b64 v[198:199], 0
    v_mov_b64 v[200:201], 0
    v_mov_b64 v[202:203], 0
    v_mov_b64 v[204:205], 0
    v_mov_b64 v[206:207], 0
    v_mov_b64 v[208:209], 0
    v_mov_b64 v[210:211], 0
    v_mov_b64 v[212:213], 0
    v_mov_b64 v[214:215], 0
    v_mov_b64 v[216:217], 0
    v_mov_b64 v[218:219], 0
    v_mov_b64 v[220:221], 0
    v_mov_b64 v[222:223], 0
    v_mov_b64 v[224:225], 0
    v_mov_b64 v[226:227], 0
    v_mov_b64 v[228:229], 0
    v_mov_b64 v[230:231], 0
    v_mov_b64 v[232:233], 0
    v_mov_b64 v[234:235], 0
    v_mov_b64 v[236:237], 0
    v_mov_b64 v[238:239], 0
    s_mov_b32 s26, 0
K3_BLOOP:
    s_cbranch_execz K3_SW1
    s_waitcnt vmcnt(8)
K3_SW1:
    s_and_b32 s27, s26, 1
    s_lshl_b32 s27, s27, 15
    v_add_u32 v240, s27, v12
    v_add_u32 v241, s27, v13
    v_add_u32 v242, s27, v14
    v_add_u32 v243, s27, v15
    v_add_u32 v244, s27, v16
    v_add_u32 v245, s27, v17
    v_add_u32 v246, s27, v18
    v_add_u32 v247, s27, v19
    ds_read_b128 v[104:107], v240
    ds_read_b128 v[108:111], v241
    ds_read_b128 v[112:115], v242
    ds_read_b128 v[116:119], v243
    ds_read_b128 v[120:123], v244
    ds_read_b128 v[124:127], v245
    ds_read_b128 v[128:131], v246
    ds_read_b128 v[132:135], v247
    v_add_u32 v248, s27, v20
    v_add_u32 v249, s27, v21
    v_add_u32 v250, s27, v22
    v_add_u32 v251, s27, v23
    v_add_u32 v252, s27, v24
    v_add_u32 v253, s27, v25
    v_add_u32 v254, s27, v26
    v_add_u32 v255, s27, v27
    s_waitcnt lgkmcnt(0)
    v_mfma_f32_32x32x16_bf16 v[64:79], v[104:107], v[32:35], 0
    v_mfma_f32_32x32x16_bf16 v[64:79], v[108:111], v[36:39], v[64:79]
    v_mfma_f32_32x32x16_bf16 v[64:79], v[112:115], v[40:43], v[64:79]
    v_mfma_f32_32x32x16_bf16 v[64:79], v[116:119], v[44:47], v[64:79]
    v_mfma_f32_32x32x16_bf16 v[64:79], v[120:123], v[48:51], v[64:79]
    v_mfma_f32_32x32x16_bf16 v[64:79], v[124:127], v[52:55], v[64:79]
    v_mfma_f32_32x32x16_bf16 v[64:79], v[128:131], v[56:59], v[64:79]
    v_mfma_f32_32x32x16_bf16 v[64:79], v[132:135], v[60:63], v[64:79]
    s_nop 7
    s_nop 3
    s_cbranch_execz K3_SB1
    s_barrier
K3_SB1:
    ds_write_b128 v4, v[64:67] offset:0
    ds_write_b128 v4, v[68:71] offset:1024
    ds_write_b128 v4, v[72:75] offset:2048
    ds_write_b128 v4, v[76:79] offset:3072
    s_waitcnt lgkmcnt(0)
    s_cbranch_execz K3_SB2
    s_barrier
K3_SB2:
    ds_read_b128 v[104:107], v28 offset:0
    ds_read_b128 v[108:111], v28 offset:1024
    ds_read_b128 v[112:115], v28 offset:2048
    ds_read_b128 v[116:119], v28 offset:3072
    ds_read_b128 v[120:123], v28 offset:4096
    ds_read_b128 v[124:127], v28 offset:5120
    ds_read_b128 v[128:131], v28 offset:6144
    ds_read_b128 v[132:135], v28 offset:7168
    ds_read_b128 v[136:139], v28 offset:8192
    ds_read_b128 v[140:143], v28 offset:9216
    ds_read_b128 v[144:147], v28 offset:10240
    ds_read_b128 v[148:151], v28 offset:11264
    ds_read_b128 v[152:155], v28 offset:12288
    ds_read_b128 v[156:159], v28 offset:13312
    ds_read_b128 v[160:163], v28 offset:14336
    ds_read_b128 v[164:167], v28 offset:15360
    s_waitcnt lgkmcnt(0)
    v_pk_add_f32 v[64:65], v[104:105], v[120:121]
    v_pk_add_f32 v[136:137], v[136:137], v[152:153]
    v_pk_add_f32 v[64:65], v[64:65], v[136:137]
    v_pk_add_f32 v[66:67], v[106:107], v[122:123]
    v_pk_add_f32 v[138:139], v[138:139], v[154:155]
    v_pk_add_f32 v[66:67], v[66:67], v[138:139]
    v_pk_add_f32 v[68:69], v[108:109], v[124:125]
    v_pk_add_f32 v[140:141], v[140:141], v[156:157]
    v_pk_add_f32 v[68:69], v[68:69], v[140:141]
    v_pk_add_f32 v[70:71], v[110:111], v[126:127]
    v_pk_add_f32 v[142:143], v[142:143], v[158:159]
    v_pk_add_f32 v[70:71], v[70:71], v[142:143]
    v_pk_add_f32 v[72:73], v[112:113], v[128:129]
    v_pk_add_f32 v[144:145], v[144:145], v[160:161]
    v_pk_add_f32 v[72:73], v[72:73], v[144:145]
    v_pk_add_f32 v[74:75], v[114:115], v[130:131]
    v_pk_add_f32 v[146:147], v[146:147], v[162:163]
    v_pk_add_f32 v[74:75], v[74:75], v[146:147]
    v_pk_add_f32 v[76:77], v[116:117], v[132:133]
    v_pk_add_f32 v[148:149], v[148:149], v[164:165]
    v_pk_add_f32 v[76:77], v[76:77], v[148:149]
    v_pk_add_f32 v[78:79], v[118:119], v[134:135]
    v_pk_add_f32 v[150:151], v[150:151], v[166:167]
    v_pk_add_f32 v[78:79], v[78:79], v[150:151]
    v_max3_f32 v5, v64, v65, v66
    v_max3_f32 v5, v5, v67, v68
    v_max3_f32 v5, v5, v69, v70
    v_max3_f32 v5, v5, v71, v72
    v_max3_f32 v5, v5, v73, v74
    v_max3_f32 v5, v5, v75, v76
    v_max3_f32 v5, v5, v77, v78
    v_max_f32 v5, v5, v79
    v_mov_b32 v6, v5
    s_nop 1
    v_permlane32_swap_b32 v5, v6
    s_nop 1
    v_max_f32 v5, v5, v6
    v_max_f32 v5, v5, v29
    v_sub_f32 v6, v29, v5
    v_exp_f32 v30, v6
    v_mov_b32 v29, v5
    v_sub_f32 v64, v64, v5
    v_exp_f32 v64, v64
    v_sub_f32 v65, v65, v5
    v_exp_f32 v65, v65
    v_sub_f32 v66, v66, v5
    v_exp_f32 v66, v66
    v_sub_f32 v67, v67, v5
    v_exp_f32 v67, v67
    v_sub_f32 v68, v68, v5
    v_exp_f32 v68, v68
    v_sub_f32 v69, v69, v5
    v_exp_f32 v69, v69
    v_sub_f32 v70, v70, v5
    v_exp_f32 v70, v70
    v_sub_f32 v71, v71, v5
    v_exp_f32 v71, v71
    v_sub_f32 v72, v72, v5
    v_exp_f32 v72, v72
    v_sub_f32 v73, v73, v5
    v_exp_f32 v73, v73
    v_sub_f32 v74, v74, v5
    v_exp_f32 v74, v74
    v_sub_f32 v75, v75, v5
    v_exp_f32 v75, v75
    v_sub_f32 v76, v76, v5
    v_exp_f32 v76, v76
    v_sub_f32 v77, v77, v5
    v_exp_f32 v77, v77
    v_sub_f32 v78, v78, v5
    v_exp_f32 v78, v78
    v_sub_f32 v79, v79, v5
    v_exp_f32 v79, v79
    v_mov_b32 v31, v30
    v_mul_f32 v174, v174, v30
    v_add_f32 v174, v174, v64
    v_add_f32 v174, v174, v65
    v_add_f32 v174, v174, v66
    v_add_f32 v174, v174, v67
    v_add_f32 v174, v174, v68
    v_add_f32 v174, v174, v69
    v_add_f32 v174, v174, v70
    v_add_f32 v174, v174, v71
    v_add_f32 v174, v174, v72
    v_add_f32 v174, v174, v73
    v_add_f32 v174, v174, v74
    v_add_f32 v174, v174, v75
    v_add_f32 v174, v174, v76
    v_add_f32 v174, v174, v77
    v_add_f32 v174, v174, v78
    v_add_f32 v174, v174, v79
    v_cvt_pk_bf16_f32 v96, v64, v65
    v_cvt_pk_bf16_f32 v97, v66, v67
    v_cvt_pk_bf16_f32 v98, v68, v69
    v_cvt_pk_bf16_f32 v99, v70, v71
    v_cvt_pk_bf16_f32 v100, v72, v73
    v_cvt_pk_bf16_f32 v101, v74, v75
    v_cvt_pk_bf16_f32 v102, v76, v77
    v_cvt_pk_bf16_f32 v103, v78, v79
    v_pk_mul_f32 v[176:177], v[176:177], v[30:31]
    v_pk_mul_f32 v[178:179], v[178:179], v[30:31]
    v_pk_mul_f32 v[180:181], v[180:181], v[30:31]
    v_pk_mul_f32 v[182:183], v[182:183], v[30:31]
    v_pk_mul_f32 v[184:185], v[184:185], v[30:31]
    v_pk_mul_f32 v[186:187], v[186:187], v[30:31]
    v_pk_mul_f32 v[188:189], v[188:189], v[30:31]
    v_pk_mul_f32 v[190:191], v[190:191], v[30:31]
    v_pk_mul_f32 v[192:193], v[192:193], v[30:31]
    v_pk_mul_f32 v[194:195], v[194:195], v[30:31]
    v_pk_mul_f32 v[196:197], v[196:197], v[30:31]
    v_pk_mul_f32 v[198:199], v[198:199], v[30:31]
    v_pk_mul_f32 v[200:201], v[200:201], v[30:31]
    v_pk_mul_f32 v[202:203], v[202:203], v[30:31]
    v_pk_mul_f32 v[204:205], v[204:205], v[30:31]
    v_pk_mul_f32 v[206:207], v[206:207], v[30:31]
    v_pk_mul_f32 v[208:209], v[208:209], v[30:31]
    v_pk_mul_f32 v[210:211], v[210:211], v[30:31]
    v_pk_mul_f32 v[212:213], v[212:213], v[30:31]
    v_pk_mul_f32 v[214:215], v[214:215], v[30:31]
    v_pk_mul_f32 v[216:217], v[216:217], v[30:31]
    v_pk_mul_f32 v[218:219], v[218:219], v[30:31]
    v_pk_mul_f32 v[220:221], v[220:221], v[30:31]
    v_pk_mul_f32 v[222:223], v[222:223], v[30:31]
    v_pk_mul_f32 v[224:225], v[224:225], v[30:31]
    v_pk_mul_f32 v[226:227], v[226:227], v[30:31]
    v_pk_mul_f32 v[228:229], v[228:229], v[30:31]
    v_pk_mul_f32 v[230:231], v[230:231], v[30:31]
    v_pk_mul_f32 v[232:233], v[232:233], v[30:31]
    v_pk_mul_f32 v[234:235], v[234:235], v[30:31]
    v_pk_mul_f32 v[236:237], v[236:237], v[30:31]
    v_pk_mul_f32 v[238:239], v[238:239], v[30:31]
    ds_read_b64_tr_b16 v[104:105], v248 offset:0
    ds_read_b64_tr_b16 v[106:107], v249 offset:0
    ds_read_b64_tr_b16 v[108:109], v248 offset:4096
    ds_read_b64_tr_b16 v[110:111], v249 offset:4096
    ds_read_b64_tr_b16 v[112:113], v250 offset:0
    ds_read_b64_tr_b16 v[114:115], v251 offset:0
    ds_read_b64_tr_b16 v[116:117], v250 offset:4096
    ds_read_b64_tr_b16 v[118:119], v251 offset:4096
    ds_read_b64_tr_b16 v[120:121], v252 offset:0
    ds_read_b64_tr_b16 v[122:123], v253 offset:0
    ds_read_b64_tr_b16 v[124:125], v252 offset:4096
    ds_read_b64_tr_b16 v[126:127], v253 offset:4096
    ds_read_b64_tr_b16 v[128:129], v254 offset:0
    ds_read_b64_tr_b16 v[130:131], v255 offset:0
    ds_read_b64_tr_b16 v[132:133], v254 offset:4096
    ds_read_b64_tr_b16 v[134:135], v255 offset:4096
    s_add_u32 s28, s26, 2
    s_lshl_b32 s24, s28, 21
    s_add_u32 s24, s24, s19
    s_cmp_lt_u32 s28, 4
    s_cselect_b32 s24, s24, 0x80000000
    s_add_u32 s23, s22, s27
    s_waitcnt lgkmcnt(0)
    s_mov_b32 m0, s23
    s_add_u32 s23, s23, 1024
    buffer_load_dwordx4 v8, s[8:11], s24 offen nt lds
    s_add_u32 s24, s24, 4096
    s_mov_b32 m0, s23
    s_add_u32 s23, s23, 1024
    buffer_load_dwordx4 v9, s[8:11], s24 offen nt lds
    s_add_u32 s24, s24, 4096
    s_mov_b32 m0, s23
    s_add_u32 s23, s23, 1024
    buffer_load_dwordx4 v10, s[8:11], s24 offen nt lds
    s_add_u32 s24, s24, 4096
    s_mov_b32 m0, s23
    s_add_u32 s23, s23, 1024
    buffer_load_dwordx4 v11, s[8:11], s24 offen nt lds
    s_add_u32 s24, s24, 4096
    s_mov_b32 m0, s23
    s_add_u32 s23, s23, 1024
    buffer_load_dwordx4 v8, s[8:11], s24 offen nt lds
    s_add_u32 s24, s24, 4096
    s_mov_b32 m0, s23
    s_add_u32 s23, s23, 1024
    buffer_load_dwordx4 v9, s[8:11], s24 offen nt lds
    s_add_u32 s24, s24, 4096
    s_mov_b32 m0, s23
    s_add_u32 s23, s23, 1024
    buffer_load_dwordx4 v10, s[8:11], s24 offen nt lds
    s_add_u32 s24, s24, 4096
    s_mov_b32 m0, s23
    s_add_u32 s23, s23, 1024
    buffer_load_dwordx4 v11, s[8:11], s24 offen nt lds
    s_add_u32 s24, s24, 4096
    v_mfma_f32_32x32x16_bf16 v[176:191], v[104:107], v[96:99], v[176:191]
    v_mfma_f32_32x32x16_bf16 v[176:191], v[108:111], v[100:103], v[176:191]
    v_mfma_f32_32x32x16_bf16 v[192:207], v[112:115], v[96:99], v[192:207]
    v_mfma_f32_32x32x16_bf16 v[192:207], v[116:119], v[100:103], v[192:207]
    v_mfma_f32_32x32x16_bf16 v[208:223], v[120:123], v[96:99], v[208:223]
    v_mfma_f32_32x32x16_bf16 v[208:223], v[124:127], v[100:103], v[208:223]
    v_mfma_f32_32x32x16_bf16 v[224:239], v[128:131], v[96:99], v[224:239]
    v_mfma_f32_32x32x16_bf16 v[224:239], v[132:135], v[100:103], v[224:239]
    s_add_u32 s26, s26, 1
    s_cmp_lt_u32 s26, 4
    s_cbranch_scc1 K3_BLOOP
    s_nop 7
    s_nop 3
    v_mov_b32 v6, v174
    s_nop 1
    v_permlane32_swap_b32 v174, v6
    s_nop 1
    v_add_f32 v174, v174, v6
    s_cbranch_execz K3_SB3
    s_waitcnt vmcnt(0)
    s_barrier
K3_SB3:
    v_lshlrev_b32 v5, 4, v1
    s_lshl_b32 s25, s18, 14
    v_add_u32 v5, s25, v5
    s_cmp_eq_u32 s30, 0
    s_cbranch_scc1 K3_BG0
    ds_write_b128 v5, v[176:179] offset:0
    ds_write_b128 v5, v[180:183] offset:1024
    ds_write_b128 v5, v[184:187] offset:2048
    ds_write_b128 v5, v[188:191] offset:3072
    ds_write_b128 v5, v[192:195] offset:4096
    ds_write_b128 v5, v[196:199] offset:5120
    ds_write_b128 v5, v[200:203] offset:6144
    ds_write_b128 v5, v[204:207] offset:7168
    ds_write_b128 v5, v[208:211] offset:8192
    ds_write_b128 v5, v[212:215] offset:9216
    ds_write_b128 v5, v[216:219] offset:10240
    ds_write_b128 v5, v[220:223] offset:11264
    ds_write_b128 v5, v[224:227] offset:12288
    ds_write_b128 v5, v[228:231] offset:13312
    ds_write_b128 v5, v[232:235] offset:14336
    ds_write_b128 v5, v[236:239] offset:15360
    ds_write_b32 v4, v29
    ds_write_b32 v4, v174 offset:1024
    s_waitcnt lgkmcnt(0)
    s_cbranch_execz K3_BG0
    s_barrier
    s_endpgm
K3_BG0:
    s_cbranch_execz K3_SB5
    s_barrier
K3_SB5:
    ds_read_b128 v[104:107], v5 offset:0
    ds_read_b128 v[108:111], v5 offset:1024
    ds_read_b128 v[112:115], v5 offset:2048
    ds_read_b128 v[116:119], v5 offset:3072
    ds_read_b128 v[120:123], v5 offset:4096
    ds_read_b128 v[124:127], v5 offset:5120
    ds_read_b128 v[128:131], v5 offset:6144
    ds_read_b128 v[132:135], v5 offset:7168
    ds_read_b128 v[136:139], v5 offset:8192
    ds_read_b128 v[140:143], v5 offset:9216
    ds_read_b128 v[144:147], v5 offset:10240
    ds_read_b128 v[148:151], v5 offset:11264
    ds_read_b128 v[152:155], v5 offset:12288
    ds_read_b128 v[156:159], v5 offset:13312
    ds_read_b128 v[160:163], v5 offset:14336
    ds_read_b128 v[164:167], v5 offset:15360
    ds_read_b32 v6, v4 offset:16384
    ds_read_b32 v7, v4 offset:17408
    s_waitcnt lgkmcnt(0)
    v_max_f32 v5, v29, v6
    v_sub_f32 v8, v29, v5
    v_sub_f32 v9, v6, v5
    v_exp_f32 v8, v8
    v_exp_f32 v10, v9
    v_mov_b32 v29, v5
    v_mov_b32 v9, v8
    v_mov_b32 v11, v10
    v_mul_f32 v174, v174, v8
    v_fmac_f32 v174, v7, v10
    v_pk_mul_f32 v[176:177], v[176:177], v[8:9]
    v_pk_fma_f32 v[176:177], v[104:105], v[10:11], v[176:177]
    v_pk_mul_f32 v[178:179], v[178:179], v[8:9]
    v_pk_fma_f32 v[178:179], v[106:107], v[10:11], v[178:179]
    v_pk_mul_f32 v[180:181], v[180:181], v[8:9]
    v_pk_fma_f32 v[180:181], v[108:109], v[10:11], v[180:181]
    v_pk_mul_f32 v[182:183], v[182:183], v[8:9]
    v_pk_fma_f32 v[182:183], v[110:111], v[10:11], v[182:183]
    v_pk_mul_f32 v[184:185], v[184:185], v[8:9]
    v_pk_fma_f32 v[184:185], v[112:113], v[10:11], v[184:185]
    v_pk_mul_f32 v[186:187], v[186:187], v[8:9]
    v_pk_fma_f32 v[186:187], v[114:115], v[10:11], v[186:187]
    v_pk_mul_f32 v[188:189], v[188:189], v[8:9]
    v_pk_fma_f32 v[188:189], v[116:117], v[10:11], v[188:189]
    v_pk_mul_f32 v[190:191], v[190:191], v[8:9]
    v_pk_fma_f32 v[190:191], v[118:119], v[10:11], v[190:191]
    v_pk_mul_f32 v[192:193], v[192:193], v[8:9]
    v_pk_fma_f32 v[192:193], v[120:121], v[10:11], v[192:193]
    v_pk_mul_f32 v[194:195], v[194:195], v[8:9]
    v_pk_fma_f32 v[194:195], v[122:123], v[10:11], v[194:195]
    v_pk_mul_f32 v[196:197], v[196:197], v[8:9]
    v_pk_fma_f32 v[196:197], v[124:125], v[10:11], v[196:197]
    v_pk_mul_f32 v[198:199], v[198:199], v[8:9]
    v_pk_fma_f32 v[198:199], v[126:127], v[10:11], v[198:199]
    v_pk_mul_f32 v[200:201], v[200:201], v[8:9]
    v_pk_fma_f32 v[200:201], v[128:129], v[10:11], v[200:201]
    v_pk_mul_f32 v[202:203], v[202:203], v[8:9]
    v_pk_fma_f32 v[202:203], v[130:131], v[10:11], v[202:203]
    v_pk_mul_f32 v[204:205], v[204:205], v[8:9]
    v_pk_fma_f32 v[204:205], v[132:133], v[10:11], v[204:205]
    v_pk_mul_f32 v[206:207], v[206:207], v[8:9]
    v_pk_fma_f32 v[206:207], v[134:135], v[10:11], v[206:207]
    v_pk_mul_f32 v[208:209], v[208:209], v[8:9]
    v_pk_fma_f32 v[208:209], v[136:137], v[10:11], v[208:209]
    v_pk_mul_f32 v[210:211], v[210:211], v[8:9]
    v_pk_fma_f32 v[210:211], v[138:139], v[10:11], v[210:211]
    v_pk_mul_f32 v[212:213], v[212:213], v[8:9]
    v_pk_fma_f32 v[212:213], v[140:141], v[10:11], v[212:213]
    v_pk_mul_f32 v[214:215], v[214:215], v[8:9]
    v_pk_fma_f32 v[214:215], v[142:143], v[10:11], v[214:215]
    v_pk_mul_f32 v[216:217], v[216:217], v[8:9]
    v_pk_fma_f32 v[216:217], v[144:145], v[10:11], v[216:217]
    v_pk_mul_f32 v[218:219], v[218:219], v[8:9]
    v_pk_fma_f32 v[218:219], v[146:147], v[10:11], v[218:219]
    v_pk_mul_f32 v[220:221], v[220:221], v[8:9]
    v_pk_fma_f32 v[220:221], v[148:149], v[10:11], v[220:221]
    v_pk_mul_f32 v[222:223], v[222:223], v[8:9]
    v_pk_fma_f32 v[222:223], v[150:151], v[10:11], v[222:223]
    v_pk_mul_f32 v[224:225], v[224:225], v[8:9]
    v_pk_fma_f32 v[224:225], v[152:153], v[10:11], v[224:225]
    v_pk_mul_f32 v[226:227], v[226:227], v[8:9]
    v_pk_fma_f32 v[226:227], v[154:155], v[10:11], v[226:227]
    v_pk_mul_f32 v[228:229], v[228:229], v[8:9]
    v_pk_fma_f32 v[228:229], v[156:157], v[10:11], v[228:229]
    v_pk_mul_f32 v[230:231], v[230:231], v[8:9]
    v_pk_fma_f32 v[230:231], v[158:159], v[10:11], v[230:231]
    v_pk_mul_f32 v[232:233], v[232:233], v[8:9]
    v_pk_fma_f32 v[232:233], v[160:161], v[10:11], v[232:233]
    v_pk_mul_f32 v[234:235], v[234:235], v[8:9]
    v_pk_fma_f32 v[234:235], v[162:163], v[10:11], v[234:235]
    v_pk_mul_f32 v[236:237], v[236:237], v[8:9]
    v_pk_fma_f32 v[236:237], v[164:165], v[10:11], v[236:237]
    v_pk_mul_f32 v[238:239], v[238:239], v[8:9]
    v_pk_fma_f32 v[238:239], v[166:167], v[10:11], v[238:239]
    v_lshlrev_b32 v5, 2, v2
    s_lshl_b32 s23, s2, 8
    s_add_u32 s23, s23, 196608
    v_cmp_gt_u32 vcc, 32, v0
    s_and_saveexec_b64 s[26:27], vcc
    buffer_store_dword v29, v5, s[12:15], s23 offen
    buffer_store_dword v174, v5, s[12:15], s23 offen offset:128
    s_mov_b64 exec, s[26:27]
    v_cvt_pk_bf16_f32 v104, v176, v177
    v_cvt_pk_bf16_f32 v105, v178, v179
    v_cvt_pk_bf16_f32 v106, v180, v181
    v_cvt_pk_bf16_f32 v107, v182, v183
    v_cvt_pk_bf16_f32 v108, v184, v185
    v_cvt_pk_bf16_f32 v109, v186, v187
    v_cvt_pk_bf16_f32 v110, v188, v189
    v_cvt_pk_bf16_f32 v111, v190, v191
    v_cvt_pk_bf16_f32 v112, v192, v193
    v_cvt_pk_bf16_f32 v113, v194, v195
    v_cvt_pk_bf16_f32 v114, v196, v197
    v_cvt_pk_bf16_f32 v115, v198, v199
    v_cvt_pk_bf16_f32 v116, v200, v201
    v_cvt_pk_bf16_f32 v117, v202, v203
    v_cvt_pk_bf16_f32 v118, v204, v205
    v_cvt_pk_bf16_f32 v119, v206, v207
    v_cvt_pk_bf16_f32 v120, v208, v209
    v_cvt_pk_bf16_f32 v121, v210, v211
    v_cvt_pk_bf16_f32 v122, v212, v213
    v_cvt_pk_bf16_f32 v123, v214, v215
    v_cvt_pk_bf16_f32 v124, v216, v217
    v_cvt_pk_bf16_f32 v125, v218, v219
    v_cvt_pk_bf16_f32 v126, v220, v221
    v_cvt_pk_bf16_f32 v127, v222, v223
    v_cvt_pk_bf16_f32 v128, v224, v225
    v_cvt_pk_bf16_f32 v129, v226, v227
    v_cvt_pk_bf16_f32 v130, v228, v229
    v_cvt_pk_bf16_f32 v131, v230, v231
    v_cvt_pk_bf16_f32 v132, v232, v233
    v_cvt_pk_bf16_f32 v133, v234, v235
    v_cvt_pk_bf16_f32 v134, v236, v237
    v_cvt_pk_bf16_f32 v135, v238, v239
    s_mul_i32 s24, s18, 8704
    s_add_u32 s24, s24, 65536
    v_mul_u32_u24 v5, 272, v2
    v_lshl_add_u32 v5, v3, 3, v5
    v_add_u32 v5, s24, v5
    ds_write_b64 v5, v[104:105] offset:0
    ds_write_b64 v5, v[106:107] offset:16
    ds_write_b64 v5, v[108:109] offset:32
    ds_write_b64 v5, v[110:111] offset:48
    ds_write_b64 v5, v[112:113] offset:64
    ds_write_b64 v5, v[114:115] offset:80
    ds_write_b64 v5, v[116:117] offset:96
    ds_write_b64 v5, v[118:119] offset:112
    ds_write_b64 v5, v[120:121] offset:128
    ds_write_b64 v5, v[122:123] offset:144
    ds_write_b64 v5, v[124:125] offset:160
    ds_write_b64 v5, v[126:127] offset:176
    ds_write_b64 v5, v[128:129] offset:192
    ds_write_b64 v5, v[130:131] offset:208
    ds_write_b64 v5, v[132:133] offset:224
    ds_write_b64 v5, v[134:135] offset:240
    v_lshrrev_b32 v6, 4, v1
    v_and_b32 v7, 15, v1
    v_mul_u32_u24 v5, 272, v6
    v_lshl_add_u32 v5, v7, 4, v5
    v_add_u32 v5, s24, v5
    v_lshlrev_b32 v6, 10, v6
    v_lshl_add_u32 v6, v7, 4, v6
    s_lshl_b32 s23, s2, 15
    s_lshl_b32 s24, s18, 8
    s_add_u32 s23, s23, s24
    s_add_u32 s23, s23, 4194304
    s_waitcnt lgkmcnt(0)
    ds_read_b128 v[104:107], v5 offset:0
    ds_read_b128 v[108:111], v5 offset:1088
    ds_read_b128 v[112:115], v5 offset:2176
    ds_read_b128 v[116:119], v5 offset:3264
    ds_read_b128 v[120:123], v5 offset:4352
    ds_read_b128 v[124:127], v5 offset:5440
    ds_read_b128 v[128:131], v5 offset:6528
    ds_read_b128 v[132:135], v5 offset:7616
    s_waitcnt lgkmcnt(0)
    buffer_store_dwordx4 v[104:107], v6, s[12:15], s23 offen
    s_add_u32 s23, s23, 4096
    buffer_store_dwordx4 v[108:111], v6, s[12:15], s23 offen
    s_add_u32 s23, s23, 4096
    buffer_store_dwordx4 v[112:115], v6, s[12:15], s23 offen
    s_add_u32 s23, s23, 4096
    buffer_store_dwordx4 v[116:119], v6, s[12:15], s23 offen
    s_add_u32 s23, s23, 4096
    buffer_store_dwordx4 v[120:123], v6, s[12:15], s23 offen
    s_add_u32 s23, s23, 4096
    buffer_store_dwordx4 v[124:127], v6, s[12:15], s23 offen
    s_add_u32 s23, s23, 4096
    buffer_store_dwordx4 v[128:131], v6, s[12:15], s23 offen
    s_add_u32 s23, s23, 4096
    buffer_store_dwordx4 v[132:135], v6, s[12:15], s23 offen
    s_endpgm
K3_A:
    s_load_dwordx2 s[4:5], s[0:1], 8
    s_load_dwordx2 s[6:7], s[0:1], 16
    s_load_dwordx2 s[28:29], s[0:1], 104
    v_lshrrev_b32 v4, 6, v0
    v_and_b32 v1, 63, v0
    v_readfirstlane_b32 s18, v4
    s_sub_u32 s16, s2, 128
    s_lshr_b32 s17, s16, 2
    s_and_b32 s19, s16, 3
    s_lshl_b32 s20, s17, 21
    s_lshl_b32 s21, s19, 17
    s_add_u32 s20, s20, s21
    s_lshl_b32 s21, s18, 14
    s_add_u32 s20, s20, s21
    s_add_u32 s20, s20, 1572864
    v_and_b32 v2, 15, v1
    v_lshrrev_b32 v3, 4, v1
    s_waitcnt lgkmcnt(0)
    s_mov_b32 s8, s4
    s_mov_b32 s9, s5
    s_mov_b32 s10, 0x4000000
    s_mov_b32 s11, 0x00020000
    s_mov_b32 s12, s6
    s_mov_b32 s13, s7
    s_mov_b32 s14, 0x4000000
    s_mov_b32 s15, 0x00020000
    s_mov_b32 s24, s28
    s_mov_b32 s25, s29
    s_mov_b32 s26, 0x10000000
    s_mov_b32 s27, 0x00020000
    v_and_b32 v4, 3, v1
    v_lshlrev_b32 v4, 8, v4
    v_lshlrev_b32 v5, 4, v3
    v_add_u32 v4, v4, v5
    s_lshl_b32 s21, s17, 10
    s_add_u32 s21, s21, 0
    buffer_load_dwordx4 v[16:19], v4, s[24:27], s21 offen offset:0
    buffer_load_dwordx4 v[20:23], v4, s[24:27], s21 offen offset:64
    buffer_load_dwordx4 v[24:27], v4, s[24:27], s21 offen offset:128
    buffer_load_dwordx4 v[28:31], v4, s[24:27], s21 offen offset:192
    v_lshl_add_u32 v6, v2, 8, v5
    s_add_u32 s22, s20, 0
    buffer_load_dwordx4 v[64:67], v6, s[8:11], s22 offen offset:0 nt
    buffer_load_dwordx4 v[68:71], v6, s[8:11], s22 offen offset:64 nt
    buffer_load_dwordx4 v[72:75], v6, s[8:11], s22 offen offset:128 nt
    buffer_load_dwordx4 v[76:79], v6, s[8:11], s22 offen offset:192 nt
    s_add_u32 s22, s20, 4096
    buffer_load_dwordx4 v[80:83], v6, s[8:11], s22 offen offset:0 nt
    buffer_load_dwordx4 v[84:87], v6, s[8:11], s22 offen offset:64 nt
    buffer_load_dwordx4 v[88:91], v6, s[8:11], s22 offen offset:128 nt
    buffer_load_dwordx4 v[92:95], v6, s[8:11], s22 offen offset:192 nt
    s_add_u32 s22, s20, 8192
    buffer_load_dwordx4 v[96:99], v6, s[8:11], s22 offen offset:0 nt
    buffer_load_dwordx4 v[100:103], v6, s[8:11], s22 offen offset:64 nt
    buffer_load_dwordx4 v[104:107], v6, s[8:11], s22 offen offset:128 nt
    buffer_load_dwordx4 v[108:111], v6, s[8:11], s22 offen offset:192 nt
    s_add_u32 s22, s20, 12288
    buffer_load_dwordx4 v[112:115], v6, s[8:11], s22 offen offset:0 nt
    buffer_load_dwordx4 v[116:119], v6, s[8:11], s22 offen offset:64 nt
    buffer_load_dwordx4 v[120:123], v6, s[8:11], s22 offen offset:128 nt
    buffer_load_dwordx4 v[124:127], v6, s[8:11], s22 offen offset:192 nt
    v_add_u32 v7, 0, v3
    v_lshlrev_b32 v7, 1, v7
    v_xor_b32 v7, v7, v2
    v_lshlrev_b32 v7, 4, v7
    v_lshl_add_u32 v10, v3, 8, v7
    v_add_u32 v7, 4, v3
    v_lshlrev_b32 v7, 1, v7
    v_xor_b32 v7, v7, v2
    v_lshlrev_b32 v7, 4, v7
    v_lshl_add_u32 v11, v3, 8, v7
    s_lshl_b32 s23, s18, 14
    s_mov_b32 s22, s23
    s_mov_b32 s21, s20
    s_mov_b32 m0, s22
    s_add_u32 s22, s22, 1024
    buffer_load_dwordx4 v10, s[12:15], s21 offen nt lds
    s_add_u32 s21, s21, 1024
    s_mov_b32 m0, s22
    s_add_u32 s22, s22, 1024
    buffer_load_dwordx4 v11, s[12:15], s21 offen nt lds
    s_add_u32 s21, s21, 1024
    s_mov_b32 m0, s22
    s_add_u32 s22, s22, 1024
    buffer_load_dwordx4 v10, s[12:15], s21 offen nt lds
    s_add_u32 s21, s21, 1024
    s_mov_b32 m0, s22
    s_add_u32 s22, s22, 1024
    buffer_load_dwordx4 v11, s[12:15], s21 offen nt lds
    s_add_u32 s21, s21, 1024
    s_mov_b32 m0, s22
    s_add_u32 s22, s22, 1024
    buffer_load_dwordx4 v10, s[12:15], s21 offen nt lds
    s_add_u32 s21, s21, 1024
    s_mov_b32 m0, s22
    s_add_u32 s22, s22, 1024
    buffer_load_dwordx4 v11, s[12:15], s21 offen nt lds
    s_add_u32 s21, s21, 1024
    s_mov_b32 m0, s22
    s_add_u32 s22, s22, 1024
    buffer_load_dwordx4 v10, s[12:15], s21 offen nt lds
    s_add_u32 s21, s21, 1024
    s_mov_b32 m0, s22
    s_add_u32 s22, s22, 1024
    buffer_load_dwordx4 v11, s[12:15], s21 offen nt lds
    s_add_u32 s21, s21, 1024
    s_mov_b32 m0, s22
    s_add_u32 s22, s22, 1024
    buffer_load_dwordx4 v10, s[12:15], s21 offen nt lds
    s_add_u32 s21, s21, 1024
    s_mov_b32 m0, s22
    s_add_u32 s22, s22, 1024
    buffer_load_dwordx4 v11, s[12:15], s21 offen nt lds
    s_add_u32 s21, s21, 1024
    s_mov_b32 m0, s22
    s_add_u32 s22, s22, 1024
    buffer_load_dwordx4 v10, s[12:15], s21 offen nt lds
    s_add_u32 s21, s21, 1024
    s_mov_b32 m0, s22
    s_add_u32 s22, s22, 1024
    buffer_load_dwordx4 v11, s[12:15], s21 offen nt lds
    s_add_u32 s21, s21, 1024
    s_mov_b32 m0, s22
    s_add_u32 s22, s22, 1024
    buffer_load_dwordx4 v10, s[12:15], s21 offen nt lds
    s_add_u32 s21, s21, 1024
    s_mov_b32 m0, s22
    s_add_u32 s22, s22, 1024
    buffer_load_dwordx4 v11, s[12:15], s21 offen nt lds
    s_add_u32 s21, s21, 1024
    s_mov_b32 m0, s22
    s_add_u32 s22, s22, 1024
    buffer_load_dwordx4 v10, s[12:15], s21 offen nt lds
    s_add_u32 s21, s21, 1024
    s_mov_b32 m0, s22
    s_add_u32 s22, s22, 1024
    buffer_load_dwordx4 v11, s[12:15], s21 offen nt lds
    s_add_u32 s21, s21, 1024
    s_waitcnt vmcnt(28)
    v_mfma_f32_16x16x32_bf16 v[128:131], v[64:67], v[16:19], 0
    v_mfma_f32_16x16x32_bf16 v[128:131], v[68:71], v[20:23], v[128:131]
    v_mfma_f32_16x16x32_bf16 v[128:131], v[72:75], v[24:27], v[128:131]
    v_mfma_f32_16x16x32_bf16 v[128:131], v[76:79], v[28:31], v[128:131]
    s_waitcnt vmcnt(24)
    v_mfma_f32_16x16x32_bf16 v[132:135], v[80:83], v[16:19], 0
    v_mfma_f32_16x16x32_bf16 v[132:135], v[84:87], v[20:23], v[132:135]
    v_mfma_f32_16x16x32_bf16 v[132:135], v[88:91], v[24:27], v[132:135]
    v_mfma_f32_16x16x32_bf16 v[132:135], v[92:95], v[28:31], v[132:135]
    s_waitcnt vmcnt(20)
    v_mfma_f32_16x16x32_bf16 v[136:139], v[96:99], v[16:19], 0
    v_mfma_f32_16x16x32_bf16 v[136:139], v[100:103], v[20:23], v[136:139]
    v_mfma_f32_16x16x32_bf16 v[136:139], v[104:107], v[24:27], v[136:139]
    v_mfma_f32_16x16x32_bf16 v[136:139], v[108:111], v[28:31], v[136:139]
    s_waitcnt vmcnt(16)
    v_mfma_f32_16x16x32_bf16 v[140:143], v[112:115], v[16:19], 0
    v_mfma_f32_16x16x32_bf16 v[140:143], v[116:119], v[20:23], v[140:143]
    v_mfma_f32_16x16x32_bf16 v[140:143], v[120:123], v[24:27], v[140:143]
    v_mfma_f32_16x16x32_bf16 v[140:143], v[124:127], v[28:31], v[140:143]
    v_lshrrev_b32 v8, 2, v2
    v_lshl_add_u32 v8, v3, 2, v8
    v_and_b32 v9, 7, v8
    v_lshlrev_b32 v9, 1, v9
    v_bfe_u32 v12, v2, 1, 1
    v_xor_b32 v9, v9, v12
    v_lshlrev_b32 v9, 4, v9
    v_lshl_add_u32 v8, v8, 8, v9
    v_and_b32 v9, 1, v2
    v_lshl_add_u32 v8, v9, 3, v8
    v_add_u32 v8, s23, v8
    v_xor_b32 v48, 0, v8
    v_xor_b32 v49, 32, v8
    v_xor_b32 v50, 64, v8
    v_xor_b32 v51, 96, v8
    v_xor_b32 v52, 128, v8
    v_xor_b32 v53, 160, v8
    v_xor_b32 v54, 192, v8
    v_xor_b32 v55, 224, v8
    v_mov_b64 v[144:145], 0
    v_mov_b64 v[146:147], 0
    v_mov_b64 v[148:149], 0
    v_mov_b64 v[150:151], 0
    v_mov_b64 v[152:153], 0
    v_mov_b64 v[154:155], 0
    v_mov_b64 v[156:157], 0
    v_mov_b64 v[158:159], 0
    v_mov_b64 v[160:161], 0
    v_mov_b64 v[162:163], 0
    v_mov_b64 v[164:165], 0
    v_mov_b64 v[166:167], 0
    v_mov_b64 v[168:169], 0
    v_mov_b64 v[170:171], 0
    v_mov_b64 v[172:173], 0
    v_mov_b64 v[174:175], 0
    s_mov_b32 s22, 0x3e0293ee
    v_mul_f32 v128, s22, v128
    v_mul_f32 v129, s22, v129
    v_mul_f32 v130, s22, v130
    v_mul_f32 v131, s22, v131
    v_mul_f32 v132, s22, v132
    v_mul_f32 v133, s22, v133
    v_mul_f32 v134, s22, v134
    v_mul_f32 v135, s22, v135
    v_mul_f32 v136, s22, v136
    v_mul_f32 v137, s22, v137
    v_mul_f32 v138, s22, v138
    v_mul_f32 v139, s22, v139
    v_mul_f32 v140, s22, v140
    v_mul_f32 v141, s22, v141
    v_mul_f32 v142, s22, v142
    v_mul_f32 v143, s22, v143
    v_max3_f32 v5, v128, v129, v130
    v_max3_f32 v5, v5, v131, v132
    v_max3_f32 v5, v5, v133, v134
    v_max3_f32 v5, v5, v135, v136
    v_max3_f32 v5, v5, v137, v138
    v_max3_f32 v5, v5, v139, v140
    v_max3_f32 v5, v5, v141, v142
    v_max_f32 v5, v5, v143
    v_mov_b32 v6, v5
    s_nop 1
    v_permlane32_swap_b32 v5, v6
    s_nop 1
    v_max_f32 v5, v5, v6
    ds_swizzle_b32 v6, v5 offset:0x401F
    s_waitcnt lgkmcnt(0)
    v_max_f32 v5, v5, v6
    v_sub_f32 v128, v128, v5
    v_exp_f32 v128, v128
    v_sub_f32 v129, v129, v5
    v_exp_f32 v129, v129
    v_sub_f32 v130, v130, v5
    v_exp_f32 v130, v130
    v_sub_f32 v131, v131, v5
    v_exp_f32 v131, v131
    v_sub_f32 v132, v132, v5
    v_exp_f32 v132, v132
    v_sub_f32 v133, v133, v5
    v_exp_f32 v133, v133
    v_sub_f32 v134, v134, v5
    v_exp_f32 v134, v134
    v_sub_f32 v135, v135, v5
    v_exp_f32 v135, v135
    v_sub_f32 v136, v136, v5
    v_exp_f32 v136, v136
    v_sub_f32 v137, v137, v5
    v_exp_f32 v137, v137
    v_sub_f32 v138, v138, v5
    v_exp_f32 v138, v138
    v_sub_f32 v139, v139, v5
    v_exp_f32 v139, v139
    v_sub_f32 v140, v140, v5
    v_exp_f32 v140, v140
    v_sub_f32 v141, v141, v5
    v_exp_f32 v141, v141
    v_sub_f32 v142, v142, v5
    v_exp_f32 v142, v142
    v_sub_f32 v143, v143, v5
    v_exp_f32 v143, v143
    v_add_f32 v7, v128, v129
    v_add_f32 v7, v7, v130
    v_add_f32 v7, v7, v131
    v_add_f32 v7, v7, v132
    v_add_f32 v7, v7, v133
    v_add_f32 v7, v7, v134
    v_add_f32 v7, v7, v135
    v_add_f32 v7, v7, v136
    v_add_f32 v7, v7, v137
    v_add_f32 v7, v7, v138
    v_add_f32 v7, v7, v139
    v_add_f32 v7, v7, v140
    v_add_f32 v7, v7, v141
    v_add_f32 v7, v7, v142
    v_add_f32 v7, v7, v143
    v_mov_b32 v6, v7
    s_nop 1
    v_permlane32_swap_b32 v7, v6
    s_nop 1
    v_add_f32 v7, v7, v6
    ds_swizzle_b32 v6, v7 offset:0x401F
    s_waitcnt lgkmcnt(0)
    v_add_f32 v7, v7, v6
    v_cvt_pk_bf16_f32 v32, v128, v129
    v_cvt_pk_bf16_f32 v33, v130, v131
    v_cvt_pk_bf16_f32 v34, v132, v133
    v_cvt_pk_bf16_f32 v35, v134, v135
    v_cvt_pk_bf16_f32 v36, v136, v137
    v_cvt_pk_bf16_f32 v37, v138, v139
    v_cvt_pk_bf16_f32 v38, v140, v141
    v_cvt_pk_bf16_f32 v39, v142, v143
    s_waitcnt vmcnt(0)
    ds_read_b64_tr_b16 v[64:65], v48 offset:0
    ds_read_b64_tr_b16 v[66:67], v48 offset:4096
    ds_read_b64_tr_b16 v[68:69], v49 offset:0
    ds_read_b64_tr_b16 v[70:71], v49 offset:4096
    ds_read_b64_tr_b16 v[72:73], v50 offset:0
    ds_read_b64_tr_b16 v[74:75], v50 offset:4096
    ds_read_b64_tr_b16 v[76:77], v51 offset:0
    ds_read_b64_tr_b16 v[78:79], v51 offset:4096
    ds_read_b64_tr_b16 v[80:81], v52 offset:0
    ds_read_b64_tr_b16 v[82:83], v52 offset:4096
    ds_read_b64_tr_b16 v[84:85], v53 offset:0
    ds_read_b64_tr_b16 v[86:87], v53 offset:4096
    ds_read_b64_tr_b16 v[88:89], v54 offset:0
    ds_read_b64_tr_b16 v[90:91], v54 offset:4096
    ds_read_b64_tr_b16 v[92:93], v55 offset:0
    ds_read_b64_tr_b16 v[94:95], v55 offset:4096
    ds_read_b64_tr_b16 v[96:97], v48 offset:8192
    ds_read_b64_tr_b16 v[98:99], v48 offset:12288
    ds_read_b64_tr_b16 v[100:101], v49 offset:8192
    ds_read_b64_tr_b16 v[102:103], v49 offset:12288
    ds_read_b64_tr_b16 v[104:105], v50 offset:8192
    ds_read_b64_tr_b16 v[106:107], v50 offset:12288
    ds_read_b64_tr_b16 v[108:109], v51 offset:8192
    ds_read_b64_tr_b16 v[110:111], v51 offset:12288
    ds_read_b64_tr_b16 v[112:113], v52 offset:8192
    ds_read_b64_tr_b16 v[114:115], v52 offset:12288
    ds_read_b64_tr_b16 v[116:117], v53 offset:8192
    ds_read_b64_tr_b16 v[118:119], v53 offset:12288
    ds_read_b64_tr_b16 v[120:121], v54 offset:8192
    ds_read_b64_tr_b16 v[122:123], v54 offset:12288
    ds_read_b64_tr_b16 v[124:125], v55 offset:8192
    ds_read_b64_tr_b16 v[126:127], v55 offset:12288
    s_waitcnt lgkmcnt(15)
    s_waitcnt lgkmcnt(0)
    v_mfma_f32_16x16x32_bf16 v[144:147], v[64:67], v[32:35], v[144:147]
    v_mfma_f32_16x16x32_bf16 v[148:151], v[68:71], v[32:35], v[148:151]
    v_mfma_f32_16x16x32_bf16 v[152:155], v[72:75], v[32:35], v[152:155]
    v_mfma_f32_16x16x32_bf16 v[156:159], v[76:79], v[32:35], v[156:159]
    v_mfma_f32_16x16x32_bf16 v[160:163], v[80:83], v[32:35], v[160:163]
    v_mfma_f32_16x16x32_bf16 v[164:167], v[84:87], v[32:35], v[164:167]
    v_mfma_f32_16x16x32_bf16 v[168:171], v[88:91], v[32:35], v[168:171]
    v_mfma_f32_16x16x32_bf16 v[172:175], v[92:95], v[32:35], v[172:175]
    s_waitcnt lgkmcnt(0)
    v_mfma_f32_16x16x32_bf16 v[144:147], v[96:99], v[36:39], v[144:147]
    v_mfma_f32_16x16x32_bf16 v[148:151], v[100:103], v[36:39], v[148:151]
    v_mfma_f32_16x16x32_bf16 v[152:155], v[104:107], v[36:39], v[152:155]
    v_mfma_f32_16x16x32_bf16 v[156:159], v[108:111], v[36:39], v[156:159]
    v_mfma_f32_16x16x32_bf16 v[160:163], v[112:115], v[36:39], v[160:163]
    v_mfma_f32_16x16x32_bf16 v[164:167], v[116:119], v[36:39], v[164:167]
    v_mfma_f32_16x16x32_bf16 v[168:171], v[120:123], v[36:39], v[168:171]
    v_mfma_f32_16x16x32_bf16 v[172:175], v[124:127], v[36:39], v[172:175]
    v_lshlrev_b32 v8, 9, v2
    v_lshl_add_u32 v8, v3, 4, v8
    s_lshl_b32 s21, s16, 3
    s_add_u32 s21, s21, s18
    s_lshl_b32 s22, s21, 11
    s_add_u32 s22, s22, 2097152
    v_lshlrev_b32 v9, 2, v2
    s_lshl_b32 s21, s21, 5
    s_add_u32 s21, s21, 229376
    v_cmp_gt_u32 vcc, 4, v2
    s_and_saveexec_b64 s[30:31], vcc
    s_nop 4
    buffer_store_dwordx4 v[144:147], v8, s[24:27], s22 offen offset:0
    buffer_store_dwordx4 v[148:151], v8, s[24:27], s22 offen offset:64
    buffer_store_dwordx4 v[152:155], v8, s[24:27], s22 offen offset:128
    buffer_store_dwordx4 v[156:159], v8, s[24:27], s22 offen offset:192
    buffer_store_dwordx4 v[160:163], v8, s[24:27], s22 offen offset:256
    buffer_store_dwordx4 v[164:167], v8, s[24:27], s22 offen offset:320
    buffer_store_dwordx4 v[168:171], v8, s[24:27], s22 offen offset:384
    buffer_store_dwordx4 v[172:175], v8, s[24:27], s22 offen offset:448
    buffer_store_dword v5, v9, s[24:27], s21 offen
    buffer_store_dword v7, v9, s[24:27], s21 offen offset:16
    s_mov_b64 exec, -1
K3_END:
    s_endpgm
.section .rodata,"a"
.p2align 6
.amdhsa_kernel k3_attn_kernel
  .amdhsa_next_free_vgpr 256
  .amdhsa_next_free_sgpr 96
  .amdhsa_accum_offset 256
  .amdhsa_group_segment_fixed_size 0
  .amdhsa_kernarg_size 112
  .amdhsa_user_sgpr_count 2
  .amdhsa_user_sgpr_kernarg_segment_ptr 1
  .amdhsa_system_sgpr_workgroup_id_x 1
.end_amdhsa_kernel
.text
.globl k4_comb_kernel
.p2align 8
.type k4_comb_kernel,@function
k4_comb_kernel:
    s_cmp_ge_u32 s2, 320
    s_cbranch_scc1 K4_END
    s_cmp_ge_u32 s2, 256
    s_cbranch_scc1 K4_A
    s_load_dwordx2 s[4:5], s[0:1], 72
    s_load_dwordx2 s[6:7], s[0:1], 104
    s_waitcnt lgkmcnt(0)
    s_mov_b32 s8, s4
    s_mov_b32 s9, s5
    s_mov_b32 s10, 0x400000
    s_mov_b32 s11, 0x00020000
    s_mov_b32 s12, s6
    s_mov_b32 s13, s7
    s_mov_b32 s14, 0x10000000
    s_mov_b32 s15, 0x00020000
    s_lshr_b32 s16, s2, 3
    s_and_b32 s17, s2, 7
    v_lshrrev_b32 v1, 4, v0
    v_lshlrev_b32 v1, 13, v1
    v_and_b32 v2, 15, v0
    v_lshlrev_b32 v2, 4, v2
    v_add_u32 v1, v1, v2
    s_lshl_b32 s18, s17, 19
    s_lshl_b32 s19, s16, 8
    s_add_u32 s18, s18, s19
    v_add_u32 v1, s18, v1
    buffer_load_dwordx4 v[64:67], v1, s[8:11], 0 offen
    s_mov_b32 s18, 0x20000
    buffer_load_dwordx4 v[68:71], v1, s[8:11], s18 offen
    s_mov_b32 s18, 0x40000
    buffer_load_dwordx4 v[72:75], v1, s[8:11], s18 offen
    s_mov_b32 s18, 0x60000
    buffer_load_dwordx4 v[76:79], v1, s[8:11], s18 offen
    v_lshrrev_b32 v2, 6, v0
    v_and_b32 v3, 31, v0
    v_lshlrev_b32 v4, 5, v2
    v_add_u32 v4, v4, v3
    v_lshlrev_b32 v4, 8, v4
    s_lshl_b32 s18, s16, 2
    s_add_u32 s18, s18, 196608
    buffer_load_dword v5, v4, s[12:15], s18 offen
    buffer_load_dword v6, v4, s[12:15], s18 offen offset:128
    v_lshlrev_b32 v7, 20, v2
    v_and_b32 v8, 63, v0
    v_lshlrev_b32 v9, 1, v8
    v_add_u32 v7, v7, v9
    s_lshl_b32 s18, s16, 10
    s_lshl_b32 s19, s17, 7
    s_add_u32 s18, s18, s19
    s_add_u32 s18, s18, 4194304
    buffer_load_ushort v16, v7, s[12:15], s18 offen
    s_add_u32 s18, s18, 32768
    buffer_load_ushort v17, v7, s[12:15], s18 offen
    s_add_u32 s18, s18, 32768
    buffer_load_ushort v18, v7, s[12:15], s18 offen
    s_add_u32 s18, s18, 32768
    buffer_load_ushort v19, v7, s[12:15], s18 offen
    s_add_u32 s18, s18, 32768
    buffer_load_ushort v20, v7, s[12:15], s18 offen
    s_add_u32 s18, s18, 32768
    buffer_load_ushort v21, v7, s[12:15], s18 offen
    s_add_u32 s18, s18, 32768
    buffer_load_ushort v22, v7, s[12:15], s18 offen
    s_add_u32 s18, s18, 32768
    buffer_load_ushort v23, v7, s[12:15], s18 offen
    s_add_u32 s18, s18, 32768
    buffer_load_ushort v24, v7, s[12:15], s18 offen
    s_add_u32 s18, s18, 32768
    buffer_load_ushort v25, v7, s[12:15], s18 offen
    s_add_u32 s18, s18, 32768
    buffer_load_ushort v26, v7, s[12:15], s18 offen
    s_add_u32 s18, s18, 32768
    buffer_load_ushort v27, v7, s[12:15], s18 offen
    s_add_u32 s18, s18, 32768
    buffer_load_ushort v28, v7, s[12:15], s18 offen
    s_add_u32 s18, s18, 32768
    buffer_load_ushort v29, v7, s[12:15], s18 offen
    s_add_u32 s18, s18, 32768
    buffer_load_ushort v30, v7, s[12:15], s18 offen
    s_add_u32 s18, s18, 32768
    buffer_load_ushort v31, v7, s[12:15], s18 offen
    s_add_u32 s18, s18, 32768
    buffer_load_ushort v32, v7, s[12:15], s18 offen
    s_add_u32 s18, s18, 32768
    buffer_load_ushort v33, v7, s[12:15], s18 offen
    s_add_u32 s18, s18, 32768
    buffer_load_ushort v34, v7, s[12:15], s18 offen
    s_add_u32 s18, s18, 32768
    buffer_load_ushort v35, v7, s[12:15], s18 offen
    s_add_u32 s18, s18, 32768
    buffer_load_ushort v36, v7, s[12:15], s18 offen
    s_add_u32 s18, s18, 32768
    buffer_load_ushort v37, v7, s[12:15], s18 offen
    s_add_u32 s18, s18, 32768
    buffer_load_ushort v38, v7, s[12:15], s18 offen
    s_add_u32 s18, s18, 32768
    buffer_load_ushort v39, v7, s[12:15], s18 offen
    s_add_u32 s18, s18, 32768
    buffer_load_ushort v40, v7, s[12:15], s18 offen
    s_add_u32 s18, s18, 32768
    buffer_load_ushort v41, v7, s[12:15], s18 offen
    s_add_u32 s18, s18, 32768
    buffer_load_ushort v42, v7, s[12:15], s18 offen
    s_add_u32 s18, s18, 32768
    buffer_load_ushort v43, v7, s[12:15], s18 offen
    s_add_u32 s18, s18, 32768
    buffer_load_ushort v44, v7, s[12:15], s18 offen
    s_add_u32 s18, s18, 32768
    buffer_load_ushort v45, v7, s[12:15], s18 offen
    s_add_u32 s18, s18, 32768
    buffer_load_ushort v46, v7, s[12:15], s18 offen
    s_add_u32 s18, s18, 32768
    buffer_load_ushort v47, v7, s[12:15], s18 offen
    s_waitcnt vmcnt(32)
    v_mov_b32 v10, v5
    ds_swizzle_b32 v11, v10 offset:0x41f
    s_waitcnt lgkmcnt(0)
    v_max_f32 v10, v10, v11
    ds_swizzle_b32 v11, v10 offset:0x81f
    s_waitcnt lgkmcnt(0)
    v_max_f32 v10, v10, v11
    ds_swizzle_b32 v11, v10 offset:0x101f
    s_waitcnt lgkmcnt(0)
    v_max_f32 v10, v10, v11
    ds_swizzle_b32 v11, v10 offset:0x201f
    s_waitcnt lgkmcnt(0)
    v_max_f32 v10, v10, v11
    ds_swizzle_b32 v11, v10 offset:0x401f
    s_waitcnt lgkmcnt(0)
    v_max_f32 v10, v10, v11
    v_sub_f32 v5, v5, v10
    v_exp_f32 v5, v5
    s_nop 0
    v_mul_f32 v6, v6, v5
    ds_swizzle_b32 v11, v6 offset:0x41f
    s_waitcnt lgkmcnt(0)
    v_add_f32 v6, v6, v11
    ds_swizzle_b32 v11, v6 offset:0x81f
    s_waitcnt lgkmcnt(0)
    v_add_f32 v6, v6, v11
    ds_swizzle_b32 v11, v6 offset:0x101f
    s_waitcnt lgkmcnt(0)
    v_add_f32 v6, v6, v11
    ds_swizzle_b32 v11, v6 offset:0x201f
    s_waitcnt lgkmcnt(0)
    v_add_f32 v6, v6, v11
    ds_swizzle_b32 v11, v6 offset:0x401f
    s_waitcnt lgkmcnt(0)
    v_add_f32 v6, v6, v11
    v_rcp_f32 v6, v6
    s_nop 0
    v_mul_f32 v5, v5, v6
    v_mov_b32 v12, 0
    s_waitcnt vmcnt(0)
    v_readlane_b32 s20, v5, 0
    v_lshlrev_b32 v16, 16, v16
    s_nop 0
    v_fmac_f32 v12, s20, v16
    v_readlane_b32 s20, v5, 1
    v_lshlrev_b32 v17, 16, v17
    s_nop 0
    v_fmac_f32 v12, s20, v17
    v_readlane_b32 s20, v5, 2
    v_lshlrev_b32 v18, 16, v18
    s_nop 0
    v_fmac_f32 v12, s20, v18
    v_readlane_b32 s20, v5, 3
    v_lshlrev_b32 v19, 16, v19
    s_nop 0
    v_fmac_f32 v12, s20, v19
    v_readlane_b32 s20, v5, 4
    v_lshlrev_b32 v20, 16, v20
    s_nop 0
    v_fmac_f32 v12, s20, v20
    v_readlane_b32 s20, v5, 5
    v_lshlrev_b32 v21, 16, v21
    s_nop 0
    v_fmac_f32 v12, s20, v21
    v_readlane_b32 s20, v5, 6
    v_lshlrev_b32 v22, 16, v22
    s_nop 0
    v_fmac_f32 v12, s20, v22
    v_readlane_b32 s20, v5, 7
    v_lshlrev_b32 v23, 16, v23
    s_nop 0
    v_fmac_f32 v12, s20, v23
    v_readlane_b32 s20, v5, 8
    v_lshlrev_b32 v24, 16, v24
    s_nop 0
    v_fmac_f32 v12, s20, v24
    v_readlane_b32 s20, v5, 9
    v_lshlrev_b32 v25, 16, v25
    s_nop 0
    v_fmac_f32 v12, s20, v25
    v_readlane_b32 s20, v5, 10
    v_lshlrev_b32 v26, 16, v26
    s_nop 0
    v_fmac_f32 v12, s20, v26
    v_readlane_b32 s20, v5, 11
    v_lshlrev_b32 v27, 16, v27
    s_nop 0
    v_fmac_f32 v12, s20, v27
    v_readlane_b32 s20, v5, 12
    v_lshlrev_b32 v28, 16, v28
    s_nop 0
    v_fmac_f32 v12, s20, v28
    v_readlane_b32 s20, v5, 13
    v_lshlrev_b32 v29, 16, v29
    s_nop 0
    v_fmac_f32 v12, s20, v29
    v_readlane_b32 s20, v5, 14
    v_lshlrev_b32 v30, 16, v30
    s_nop 0
    v_fmac_f32 v12, s20, v30
    v_readlane_b32 s20, v5, 15
    v_lshlrev_b32 v31, 16, v31
    s_nop 0
    v_fmac_f32 v12, s20, v31
    v_readlane_b32 s20, v5, 16
    v_lshlrev_b32 v32, 16, v32
    s_nop 0
    v_fmac_f32 v12, s20, v32
    v_readlane_b32 s20, v5, 17
    v_lshlrev_b32 v33, 16, v33
    s_nop 0
    v_fmac_f32 v12, s20, v33
    v_readlane_b32 s20, v5, 18
    v_lshlrev_b32 v34, 16, v34
    s_nop 0
    v_fmac_f32 v12, s20, v34
    v_readlane_b32 s20, v5, 19
    v_lshlrev_b32 v35, 16, v35
    s_nop 0
    v_fmac_f32 v12, s20, v35
    v_readlane_b32 s20, v5, 20
    v_lshlrev_b32 v36, 16, v36
    s_nop 0
    v_fmac_f32 v12, s20, v36
    v_readlane_b32 s20, v5, 21
    v_lshlrev_b32 v37, 16, v37
    s_nop 0
    v_fmac_f32 v12, s20, v37
    v_readlane_b32 s20, v5, 22
    v_lshlrev_b32 v38, 16, v38
    s_nop 0
    v_fmac_f32 v12, s20, v38
    v_readlane_b32 s20, v5, 23
    v_lshlrev_b32 v39, 16, v39
    s_nop 0
    v_fmac_f32 v12, s20, v39
    v_readlane_b32 s20, v5, 24
    v_lshlrev_b32 v40, 16, v40
    s_nop 0
    v_fmac_f32 v12, s20, v40
    v_readlane_b32 s20, v5, 25
    v_lshlrev_b32 v41, 16, v41
    s_nop 0
    v_fmac_f32 v12, s20, v41
    v_readlane_b32 s20, v5, 26
    v_lshlrev_b32 v42, 16, v42
    s_nop 0
    v_fmac_f32 v12, s20, v42
    v_readlane_b32 s20, v5, 27
    v_lshlrev_b32 v43, 16, v43
    s_nop 0
    v_fmac_f32 v12, s20, v43
    v_readlane_b32 s20, v5, 28
    v_lshlrev_b32 v44, 16, v44
    s_nop 0
    v_fmac_f32 v12, s20, v44
    v_readlane_b32 s20, v5, 29
    v_lshlrev_b32 v45, 16, v45
    s_nop 0
    v_fmac_f32 v12, s20, v45
    v_readlane_b32 s20, v5, 30
    v_lshlrev_b32 v46, 16, v46
    s_nop 0
    v_fmac_f32 v12, s20, v46
    v_readlane_b32 s20, v5, 31
    v_lshlrev_b32 v47, 16, v47
    s_nop 0
    v_fmac_f32 v12, s20, v47
    v_lshlrev_b32 v8, 4, v8
    v_lshlrev_b32 v9, 2, v2
    v_add_u32 v8, v8, v9
    ds_write_b32 v8, v12 offset:0
    s_waitcnt lgkmcnt(0)
    s_barrier
    v_lshrrev_b32 v128, 4, v0
    v_lshlrev_b32 v129, 4, v128
    ds_read_b128 v[80:83], v129 offset:0
    ds_read_b128 v[84:87], v129 offset:256
    ds_read_b128 v[88:91], v129 offset:512
    ds_read_b128 v[92:95], v129 offset:768
    v_mov_b32 v96, 0
    v_mov_b32 v97, 0
    v_mov_b32 v98, 0
    v_mov_b32 v99, 0
    v_mov_b32 v100, 0
    v_mov_b32 v101, 0
    v_mov_b32 v102, 0
    v_mov_b32 v103, 0
    v_mov_b32 v104, 0
    v_mov_b32 v105, 0
    v_mov_b32 v106, 0
    v_mov_b32 v107, 0
    v_mov_b32 v108, 0
    v_mov_b32 v109, 0
    v_mov_b32 v110, 0
    v_mov_b32 v111, 0
    v_mov_b32 v112, 0
    v_mov_b32 v113, 0
    v_mov_b32 v114, 0
    v_mov_b32 v115, 0
    v_mov_b32 v116, 0
    v_mov_b32 v117, 0
    v_mov_b32 v118, 0
    v_mov_b32 v119, 0
    v_mov_b32 v120, 0
    v_mov_b32 v121, 0
    v_mov_b32 v122, 0
    v_mov_b32 v123, 0
    v_mov_b32 v124, 0
    v_mov_b32 v125, 0
    v_mov_b32 v126, 0
    v_mov_b32 v127, 0
    s_waitcnt lgkmcnt(0)
    s_waitcnt vmcnt(3)
    v_lshlrev_b32 v130, 16, v64
    v_and_b32 v131, 0xffff0000, v64
    v_fmac_f32 v96, v80, v130
    v_fmac_f32 v97, v80, v131
    v_fmac_f32 v104, v81, v130
    v_fmac_f32 v105, v81, v131
    v_fmac_f32 v112, v82, v130
    v_fmac_f32 v113, v82, v131
    v_fmac_f32 v120, v83, v130
    v_fmac_f32 v121, v83, v131
    v_lshlrev_b32 v130, 16, v65
    v_and_b32 v131, 0xffff0000, v65
    v_fmac_f32 v98, v80, v130
    v_fmac_f32 v99, v80, v131
    v_fmac_f32 v106, v81, v130
    v_fmac_f32 v107, v81, v131
    v_fmac_f32 v114, v82, v130
    v_fmac_f32 v115, v82, v131
    v_fmac_f32 v122, v83, v130
    v_fmac_f32 v123, v83, v131
    v_lshlrev_b32 v130, 16, v66
    v_and_b32 v131, 0xffff0000, v66
    v_fmac_f32 v100, v80, v130
    v_fmac_f32 v101, v80, v131
    v_fmac_f32 v108, v81, v130
    v_fmac_f32 v109, v81, v131
    v_fmac_f32 v116, v82, v130
    v_fmac_f32 v117, v82, v131
    v_fmac_f32 v124, v83, v130
    v_fmac_f32 v125, v83, v131
    v_lshlrev_b32 v130, 16, v67
    v_and_b32 v131, 0xffff0000, v67
    v_fmac_f32 v102, v80, v130
    v_fmac_f32 v103, v80, v131
    v_fmac_f32 v110, v81, v130
    v_fmac_f32 v111, v81, v131
    v_fmac_f32 v118, v82, v130
    v_fmac_f32 v119, v82, v131
    v_fmac_f32 v126, v83, v130
    v_fmac_f32 v127, v83, v131
    s_waitcnt vmcnt(2)
    v_lshlrev_b32 v130, 16, v68
    v_and_b32 v131, 0xffff0000, v68
    v_fmac_f32 v96, v84, v130
    v_fmac_f32 v97, v84, v131
    v_fmac_f32 v104, v85, v130
    v_fmac_f32 v105, v85, v131
    v_fmac_f32 v112, v86, v130
    v_fmac_f32 v113, v86, v131
    v_fmac_f32 v120, v87, v130
    v_fmac_f32 v121, v87, v131
    v_lshlrev_b32 v130, 16, v69
    v_and_b32 v131, 0xffff0000, v69
    v_fmac_f32 v98, v84, v130
    v_fmac_f32 v99, v84, v131
    v_fmac_f32 v106, v85, v130
    v_fmac_f32 v107, v85, v131
    v_fmac_f32 v114, v86, v130
    v_fmac_f32 v115, v86, v131
    v_fmac_f32 v122, v87, v130
    v_fmac_f32 v123, v87, v131
    v_lshlrev_b32 v130, 16, v70
    v_and_b32 v131, 0xffff0000, v70
    v_fmac_f32 v100, v84, v130
    v_fmac_f32 v101, v84, v131
    v_fmac_f32 v108, v85, v130
    v_fmac_f32 v109, v85, v131
    v_fmac_f32 v116, v86, v130
    v_fmac_f32 v117, v86, v131
    v_fmac_f32 v124, v87, v130
    v_fmac_f32 v125, v87, v131
    v_lshlrev_b32 v130, 16, v71
    v_and_b32 v131, 0xffff0000, v71
    v_fmac_f32 v102, v84, v130
    v_fmac_f32 v103, v84, v131
    v_fmac_f32 v110, v85, v130
    v_fmac_f32 v111, v85, v131
    v_fmac_f32 v118, v86, v130
    v_fmac_f32 v119, v86, v131
    v_fmac_f32 v126, v87, v130
    v_fmac_f32 v127, v87, v131
    s_waitcnt vmcnt(1)
    v_lshlrev_b32 v130, 16, v72
    v_and_b32 v131, 0xffff0000, v72
    v_fmac_f32 v96, v88, v130
    v_fmac_f32 v97, v88, v131
    v_fmac_f32 v104, v89, v130
    v_fmac_f32 v105, v89, v131
    v_fmac_f32 v112, v90, v130
    v_fmac_f32 v113, v90, v131
    v_fmac_f32 v120, v91, v130
    v_fmac_f32 v121, v91, v131
    v_lshlrev_b32 v130, 16, v73
    v_and_b32 v131, 0xffff0000, v73
    v_fmac_f32 v98, v88, v130
    v_fmac_f32 v99, v88, v131
    v_fmac_f32 v106, v89, v130
    v_fmac_f32 v107, v89, v131
    v_fmac_f32 v114, v90, v130
    v_fmac_f32 v115, v90, v131
    v_fmac_f32 v122, v91, v130
    v_fmac_f32 v123, v91, v131
    v_lshlrev_b32 v130, 16, v74
    v_and_b32 v131, 0xffff0000, v74
    v_fmac_f32 v100, v88, v130
    v_fmac_f32 v101, v88, v131
    v_fmac_f32 v108, v89, v130
    v_fmac_f32 v109, v89, v131
    v_fmac_f32 v116, v90, v130
    v_fmac_f32 v117, v90, v131
    v_fmac_f32 v124, v91, v130
    v_fmac_f32 v125, v91, v131
    v_lshlrev_b32 v130, 16, v75
    v_and_b32 v131, 0xffff0000, v75
    v_fmac_f32 v102, v88, v130
    v_fmac_f32 v103, v88, v131
    v_fmac_f32 v110, v89, v130
    v_fmac_f32 v111, v89, v131
    v_fmac_f32 v118, v90, v130
    v_fmac_f32 v119, v90, v131
    v_fmac_f32 v126, v91, v130
    v_fmac_f32 v127, v91, v131
    s_waitcnt vmcnt(0)
    v_lshlrev_b32 v130, 16, v76
    v_and_b32 v131, 0xffff0000, v76
    v_fmac_f32 v96, v92, v130
    v_fmac_f32 v97, v92, v131
    v_fmac_f32 v104, v93, v130
    v_fmac_f32 v105, v93, v131
    v_fmac_f32 v112, v94, v130
    v_fmac_f32 v113, v94, v131
    v_fmac_f32 v120, v95, v130
    v_fmac_f32 v121, v95, v131
    v_lshlrev_b32 v130, 16, v77
    v_and_b32 v131, 0xffff0000, v77
    v_fmac_f32 v98, v92, v130
    v_fmac_f32 v99, v92, v131
    v_fmac_f32 v106, v93, v130
    v_fmac_f32 v107, v93, v131
    v_fmac_f32 v114, v94, v130
    v_fmac_f32 v115, v94, v131
    v_fmac_f32 v122, v95, v130
    v_fmac_f32 v123, v95, v131
    v_lshlrev_b32 v130, 16, v78
    v_and_b32 v131, 0xffff0000, v78
    v_fmac_f32 v100, v92, v130
    v_fmac_f32 v101, v92, v131
    v_fmac_f32 v108, v93, v130
    v_fmac_f32 v109, v93, v131
    v_fmac_f32 v116, v94, v130
    v_fmac_f32 v117, v94, v131
    v_fmac_f32 v124, v95, v130
    v_fmac_f32 v125, v95, v131
    v_lshlrev_b32 v130, 16, v79
    v_and_b32 v131, 0xffff0000, v79
    v_fmac_f32 v102, v92, v130
    v_fmac_f32 v103, v92, v131
    v_fmac_f32 v110, v93, v130
    v_fmac_f32 v111, v93, v131
    v_fmac_f32 v118, v94, v130
    v_fmac_f32 v119, v94, v131
    v_fmac_f32 v126, v95, v130
    v_fmac_f32 v127, v95, v131
    v_and_b32 v129, 15, v0
    v_lshlrev_b32 v129, 5, v129
    v_mul_u32_u24 v130, 2048, v128
    v_add_u32 v129, v129, v130
    ds_write_b128 v129, v[96:99] offset:4096
    ds_write_b128 v129, v[100:103] offset:4112
    ds_write_b128 v129, v[104:107] offset:4608
    ds_write_b128 v129, v[108:111] offset:4624
    ds_write_b128 v129, v[112:115] offset:5120
    ds_write_b128 v129, v[116:119] offset:5136
    ds_write_b128 v129, v[120:123] offset:5632
    ds_write_b128 v129, v[124:127] offset:5648
    s_waitcnt lgkmcnt(0)
    s_barrier
    v_lshlrev_b32 v129, 2, v0
    ds_read_b32 v80, v129 offset:4096
    ds_read_b32 v81, v129 offset:6144
    ds_read_b32 v82, v129 offset:8192
    ds_read_b32 v83, v129 offset:10240
    ds_read_b32 v84, v129 offset:12288
    ds_read_b32 v85, v129 offset:14336
    ds_read_b32 v86, v129 offset:16384
    ds_read_b32 v87, v129 offset:18432
    ds_read_b32 v88, v129 offset:20480
    ds_read_b32 v89, v129 offset:22528
    ds_read_b32 v90, v129 offset:24576
    ds_read_b32 v91, v129 offset:26624
    ds_read_b32 v92, v129 offset:28672
    ds_read_b32 v93, v129 offset:30720
    ds_read_b32 v94, v129 offset:32768
    ds_read_b32 v95, v129 offset:34816
    ds_read_b32 v96, v129 offset:5120
    ds_read_b32 v97, v129 offset:7168
    ds_read_b32 v98, v129 offset:9216
    ds_read_b32 v99, v129 offset:11264
    ds_read_b32 v100, v129 offset:13312
    ds_read_b32 v101, v129 offset:15360
    ds_read_b32 v102, v129 offset:17408
    ds_read_b32 v103, v129 offset:19456
    ds_read_b32 v104, v129 offset:21504
    ds_read_b32 v105, v129 offset:23552
    ds_read_b32 v106, v129 offset:25600
    ds_read_b32 v107, v129 offset:27648
    ds_read_b32 v108, v129 offset:29696
    ds_read_b32 v109, v129 offset:31744
    ds_read_b32 v110, v129 offset:33792
    ds_read_b32 v111, v129 offset:35840
    s_waitcnt lgkmcnt(0)
    v_add_f32 v130, v80, v81
    v_add_f32 v130, v130, v82
    v_add_f32 v130, v130, v83
    v_add_f32 v130, v130, v84
    v_add_f32 v130, v130, v85
    v_add_f32 v130, v130, v86
    v_add_f32 v130, v130, v87
    v_add_f32 v130, v130, v88
    v_add_f32 v130, v130, v89
    v_add_f32 v130, v130, v90
    v_add_f32 v130, v130, v91
    v_add_f32 v130, v130, v92
    v_add_f32 v130, v130, v93
    v_add_f32 v130, v130, v94
    v_add_f32 v130, v130, v95
    v_add_f32 v131, v96, v97
    v_add_f32 v131, v131, v98
    v_add_f32 v131, v131, v99
    v_add_f32 v131, v131, v100
    v_add_f32 v131, v131, v101
    v_add_f32 v131, v131, v102
    v_add_f32 v131, v131, v103
    v_add_f32 v131, v131, v104
    v_add_f32 v131, v131, v105
    v_add_f32 v131, v131, v106
    v_add_f32 v131, v131, v107
    v_add_f32 v131, v131, v108
    v_add_f32 v131, v131, v109
    v_add_f32 v131, v131, v110
    v_add_f32 v131, v131, v111
    v_lshrrev_b32 v1, 7, v0
    v_lshlrev_b32 v1, 14, v1
    v_and_b32 v2, 127, v0
    v_lshlrev_b32 v2, 2, v2
    v_add_u32 v1, v1, v2
    s_lshl_b32 s18, s17, 16
    s_lshl_b32 s19, s16, 9
    s_add_u32 s18, s18, s19
    s_add_u32 s18, s18, 327680
    buffer_store_dword v130, v1, s[12:15], s18 offen
    s_add_u32 s18, s18, 32768
    buffer_store_dword v131, v1, s[12:15], s18 offen
    s_endpgm
K4_A:
    s_load_dwordx2 s[6:7], s[0:1], 104
    s_waitcnt lgkmcnt(0)
    s_mov_b32 s12, s6
    s_mov_b32 s13, s7
    s_mov_b32 s14, 0x10000000
    s_mov_b32 s15, 0x00020000
    s_sub_u32 s16, s2, 256
    s_lshl_b32 s16, s16, 8
    v_add_u32 v1, s16, v0
    v_lshrrev_b32 v2, 7, v1
    v_and_b32 v3, 127, v1
    v_lshrrev_b32 v4, 2, v2
    v_and_b32 v5, 3, v2
    v_lshlrev_b32 v6, 10, v4
    v_lshlrev_b32 v7, 2, v5
    v_add_u32 v6, v6, v7
    s_mov_b32 s18, 229376
    buffer_load_dword v16, v6, s[12:15], s18 offen offset:0
    buffer_load_dword v48, v6, s[12:15], s18 offen offset:16
    buffer_load_dword v17, v6, s[12:15], s18 offen offset:32
    buffer_load_dword v49, v6, s[12:15], s18 offen offset:48
    buffer_load_dword v18, v6, s[12:15], s18 offen offset:64
    buffer_load_dword v50, v6, s[12:15], s18 offen offset:80
    buffer_load_dword v19, v6, s[12:15], s18 offen offset:96
    buffer_load_dword v51, v6, s[12:15], s18 offen offset:112
    buffer_load_dword v20, v6, s[12:15], s18 offen offset:128
    buffer_load_dword v52, v6, s[12:15], s18 offen offset:144
    buffer_load_dword v21, v6, s[12:15], s18 offen offset:160
    buffer_load_dword v53, v6, s[12:15], s18 offen offset:176
    buffer_load_dword v22, v6, s[12:15], s18 offen offset:192
    buffer_load_dword v54, v6, s[12:15], s18 offen offset:208
    buffer_load_dword v23, v6, s[12:15], s18 offen offset:224
    buffer_load_dword v55, v6, s[12:15], s18 offen offset:240
    buffer_load_dword v24, v6, s[12:15], s18 offen offset:256
    buffer_load_dword v56, v6, s[12:15], s18 offen offset:272
    buffer_load_dword v25, v6, s[12:15], s18 offen offset:288
    buffer_load_dword v57, v6, s[12:15], s18 offen offset:304
    buffer_load_dword v26, v6, s[12:15], s18 offen offset:320
    buffer_load_dword v58, v6, s[12:15], s18 offen offset:336
    buffer_load_dword v27, v6, s[12:15], s18 offen offset:352
    buffer_load_dword v59, v6, s[12:15], s18 offen offset:368
    buffer_load_dword v28, v6, s[12:15], s18 offen offset:384
    buffer_load_dword v60, v6, s[12:15], s18 offen offset:400
    buffer_load_dword v29, v6, s[12:15], s18 offen offset:416
    buffer_load_dword v61, v6, s[12:15], s18 offen offset:432
    buffer_load_dword v30, v6, s[12:15], s18 offen offset:448
    buffer_load_dword v62, v6, s[12:15], s18 offen offset:464
    buffer_load_dword v31, v6, s[12:15], s18 offen offset:480
    buffer_load_dword v63, v6, s[12:15], s18 offen offset:496
    buffer_load_dword v32, v6, s[12:15], s18 offen offset:512
    buffer_load_dword v64, v6, s[12:15], s18 offen offset:528
    buffer_load_dword v33, v6, s[12:15], s18 offen offset:544
    buffer_load_dword v65, v6, s[12:15], s18 offen offset:560
    buffer_load_dword v34, v6, s[12:15], s18 offen offset:576
    buffer_load_dword v66, v6, s[12:15], s18 offen offset:592
    buffer_load_dword v35, v6, s[12:15], s18 offen offset:608
    buffer_load_dword v67, v6, s[12:15], s18 offen offset:624
    buffer_load_dword v36, v6, s[12:15], s18 offen offset:640
    buffer_load_dword v68, v6, s[12:15], s18 offen offset:656
    buffer_load_dword v37, v6, s[12:15], s18 offen offset:672
    buffer_load_dword v69, v6, s[12:15], s18 offen offset:688
    buffer_load_dword v38, v6, s[12:15], s18 offen offset:704
    buffer_load_dword v70, v6, s[12:15], s18 offen offset:720
    buffer_load_dword v39, v6, s[12:15], s18 offen offset:736
    buffer_load_dword v71, v6, s[12:15], s18 offen offset:752
    buffer_load_dword v40, v6, s[12:15], s18 offen offset:768
    buffer_load_dword v72, v6, s[12:15], s18 offen offset:784
    buffer_load_dword v41, v6, s[12:15], s18 offen offset:800
    buffer_load_dword v73, v6, s[12:15], s18 offen offset:816
    buffer_load_dword v42, v6, s[12:15], s18 offen offset:832
    buffer_load_dword v74, v6, s[12:15], s18 offen offset:848
    buffer_load_dword v43, v6, s[12:15], s18 offen offset:864
    buffer_load_dword v75, v6, s[12:15], s18 offen offset:880
    buffer_load_dword v44, v6, s[12:15], s18 offen offset:896
    buffer_load_dword v76, v6, s[12:15], s18 offen offset:912
    buffer_load_dword v45, v6, s[12:15], s18 offen offset:928
    buffer_load_dword v77, v6, s[12:15], s18 offen offset:944
    buffer_load_dword v46, v6, s[12:15], s18 offen offset:960
    buffer_load_dword v78, v6, s[12:15], s18 offen offset:976
    buffer_load_dword v47, v6, s[12:15], s18 offen offset:992
    buffer_load_dword v79, v6, s[12:15], s18 offen offset:1008
    v_lshlrev_b32 v8, 16, v4
    v_lshlrev_b32 v9, 9, v5
    v_add_u32 v8, v8, v9
    v_lshlrev_b32 v9, 2, v3
    v_add_u32 v8, v8, v9
    s_mov_b32 s18, 2097152
    buffer_load_dword v80, v8, s[12:15], s18 offen
    s_add_u32 s18, s18, 2048
    buffer_load_dword v81, v8, s[12:15], s18 offen
    s_add_u32 s18, s18, 2048
    buffer_load_dword v82, v8, s[12:15], s18 offen
    s_add_u32 s18, s18, 2048
    buffer_load_dword v83, v8, s[12:15], s18 offen
    s_add_u32 s18, s18, 2048
    buffer_load_dword v84, v8, s[12:15], s18 offen
    s_add_u32 s18, s18, 2048
    buffer_load_dword v85, v8, s[12:15], s18 offen
    s_add_u32 s18, s18, 2048
    buffer_load_dword v86, v8, s[12:15], s18 offen
    s_add_u32 s18, s18, 2048
    buffer_load_dword v87, v8, s[12:15], s18 offen
    s_add_u32 s18, s18, 2048
    buffer_load_dword v88, v8, s[12:15], s18 offen
    s_add_u32 s18, s18, 2048
    buffer_load_dword v89, v8, s[12:15], s18 offen
    s_add_u32 s18, s18, 2048
    buffer_load_dword v90, v8, s[12:15], s18 offen
    s_add_u32 s18, s18, 2048
    buffer_load_dword v91, v8, s[12:15], s18 offen
    s_add_u32 s18, s18, 2048
    buffer_load_dword v92, v8, s[12:15], s18 offen
    s_add_u32 s18, s18, 2048
    buffer_load_dword v93, v8, s[12:15], s18 offen
    s_add_u32 s18, s18, 2048
    buffer_load_dword v94, v8, s[12:15], s18 offen
    s_add_u32 s18, s18, 2048
    buffer_load_dword v95, v8, s[12:15], s18 offen
    s_add_u32 s18, s18, 2048
    buffer_load_dword v96, v8, s[12:15], s18 offen
    s_add_u32 s18, s18, 2048
    buffer_load_dword v97, v8, s[12:15], s18 offen
    s_add_u32 s18, s18, 2048
    buffer_load_dword v98, v8, s[12:15], s18 offen
    s_add_u32 s18, s18, 2048
    buffer_load_dword v99, v8, s[12:15], s18 offen
    s_add_u32 s18, s18, 2048
    buffer_load_dword v100, v8, s[12:15], s18 offen
    s_add_u32 s18, s18, 2048
    buffer_load_dword v101, v8, s[12:15], s18 offen
    s_add_u32 s18, s18, 2048
    buffer_load_dword v102, v8, s[12:15], s18 offen
    s_add_u32 s18, s18, 2048
    buffer_load_dword v103, v8, s[12:15], s18 offen
    s_add_u32 s18, s18, 2048
    buffer_load_dword v104, v8, s[12:15], s18 offen
    s_add_u32 s18, s18, 2048
    buffer_load_dword v105, v8, s[12:15], s18 offen
    s_add_u32 s18, s18, 2048
    buffer_load_dword v106, v8, s[12:15], s18 offen
    s_add_u32 s18, s18, 2048
    buffer_load_dword v107, v8, s[12:15], s18 offen
    s_add_u32 s18, s18, 2048
    buffer_load_dword v108, v8, s[12:15], s18 offen
    s_add_u32 s18, s18, 2048
    buffer_load_dword v109, v8, s[12:15], s18 offen
    s_add_u32 s18, s18, 2048
    buffer_load_dword v110, v8, s[12:15], s18 offen
    s_add_u32 s18, s18, 2048
    buffer_load_dword v111, v8, s[12:15], s18 offen
    s_waitcnt vmcnt(32)
    v_max_f32 v10, v16, v17
    v_max_f32 v10, v10, v18
    v_max_f32 v10, v10, v19
    v_max_f32 v10, v10, v20
    v_max_f32 v10, v10, v21
    v_max_f32 v10, v10, v22
    v_max_f32 v10, v10, v23
    v_max_f32 v10, v10, v24
    v_max_f32 v10, v10, v25
    v_max_f32 v10, v10, v26
    v_max_f32 v10, v10, v27
    v_max_f32 v10, v10, v28
    v_max_f32 v10, v10, v29
    v_max_f32 v10, v10, v30
    v_max_f32 v10, v10, v31
    v_max_f32 v10, v10, v32
    v_max_f32 v10, v10, v33
    v_max_f32 v10, v10, v34
    v_max_f32 v10, v10, v35
    v_max_f32 v10, v10, v36
    v_max_f32 v10, v10, v37
    v_max_f32 v10, v10, v38
    v_max_f32 v10, v10, v39
    v_max_f32 v10, v10, v40
    v_max_f32 v10, v10, v41
    v_max_f32 v10, v10, v42
    v_max_f32 v10, v10, v43
    v_max_f32 v10, v10, v44
    v_max_f32 v10, v10, v45
    v_max_f32 v10, v10, v46
    v_max_f32 v10, v10, v47
    v_mov_b32 v11, 0
    v_sub_f32 v16, v16, v10
    v_exp_f32 v16, v16
    s_nop 0
    v_fmac_f32 v11, v16, v48
    v_sub_f32 v17, v17, v10
    v_exp_f32 v17, v17
    s_nop 0
    v_fmac_f32 v11, v17, v49
    v_sub_f32 v18, v18, v10
    v_exp_f32 v18, v18
    s_nop 0
    v_fmac_f32 v11, v18, v50
    v_sub_f32 v19, v19, v10
    v_exp_f32 v19, v19
    s_nop 0
    v_fmac_f32 v11, v19, v51
    v_sub_f32 v20, v20, v10
    v_exp_f32 v20, v20
    s_nop 0
    v_fmac_f32 v11, v20, v52
    v_sub_f32 v21, v21, v10
    v_exp_f32 v21, v21
    s_nop 0
    v_fmac_f32 v11, v21, v53
    v_sub_f32 v22, v22, v10
    v_exp_f32 v22, v22
    s_nop 0
    v_fmac_f32 v11, v22, v54
    v_sub_f32 v23, v23, v10
    v_exp_f32 v23, v23
    s_nop 0
    v_fmac_f32 v11, v23, v55
    v_sub_f32 v24, v24, v10
    v_exp_f32 v24, v24
    s_nop 0
    v_fmac_f32 v11, v24, v56
    v_sub_f32 v25, v25, v10
    v_exp_f32 v25, v25
    s_nop 0
    v_fmac_f32 v11, v25, v57
    v_sub_f32 v26, v26, v10
    v_exp_f32 v26, v26
    s_nop 0
    v_fmac_f32 v11, v26, v58
    v_sub_f32 v27, v27, v10
    v_exp_f32 v27, v27
    s_nop 0
    v_fmac_f32 v11, v27, v59
    v_sub_f32 v28, v28, v10
    v_exp_f32 v28, v28
    s_nop 0
    v_fmac_f32 v11, v28, v60
    v_sub_f32 v29, v29, v10
    v_exp_f32 v29, v29
    s_nop 0
    v_fmac_f32 v11, v29, v61
    v_sub_f32 v30, v30, v10
    v_exp_f32 v30, v30
    s_nop 0
    v_fmac_f32 v11, v30, v62
    v_sub_f32 v31, v31, v10
    v_exp_f32 v31, v31
    s_nop 0
    v_fmac_f32 v11, v31, v63
    v_sub_f32 v32, v32, v10
    v_exp_f32 v32, v32
    s_nop 0
    v_fmac_f32 v11, v32, v64
    v_sub_f32 v33, v33, v10
    v_exp_f32 v33, v33
    s_nop 0
    v_fmac_f32 v11, v33, v65
    v_sub_f32 v34, v34, v10
    v_exp_f32 v34, v34
    s_nop 0
    v_fmac_f32 v11, v34, v66
    v_sub_f32 v35, v35, v10
    v_exp_f32 v35, v35
    s_nop 0
    v_fmac_f32 v11, v35, v67
    v_sub_f32 v36, v36, v10
    v_exp_f32 v36, v36
    s_nop 0
    v_fmac_f32 v11, v36, v68
    v_sub_f32 v37, v37, v10
    v_exp_f32 v37, v37
    s_nop 0
    v_fmac_f32 v11, v37, v69
    v_sub_f32 v38, v38, v10
    v_exp_f32 v38, v38
    s_nop 0
    v_fmac_f32 v11, v38, v70
    v_sub_f32 v39, v39, v10
    v_exp_f32 v39, v39
    s_nop 0
    v_fmac_f32 v11, v39, v71
    v_sub_f32 v40, v40, v10
    v_exp_f32 v40, v40
    s_nop 0
    v_fmac_f32 v11, v40, v72
    v_sub_f32 v41, v41, v10
    v_exp_f32 v41, v41
    s_nop 0
    v_fmac_f32 v11, v41, v73
    v_sub_f32 v42, v42, v10
    v_exp_f32 v42, v42
    s_nop 0
    v_fmac_f32 v11, v42, v74
    v_sub_f32 v43, v43, v10
    v_exp_f32 v43, v43
    s_nop 0
    v_fmac_f32 v11, v43, v75
    v_sub_f32 v44, v44, v10
    v_exp_f32 v44, v44
    s_nop 0
    v_fmac_f32 v11, v44, v76
    v_sub_f32 v45, v45, v10
    v_exp_f32 v45, v45
    s_nop 0
    v_fmac_f32 v11, v45, v77
    v_sub_f32 v46, v46, v10
    v_exp_f32 v46, v46
    s_nop 0
    v_fmac_f32 v11, v46, v78
    v_sub_f32 v47, v47, v10
    v_exp_f32 v47, v47
    s_nop 0
    v_fmac_f32 v11, v47, v79
    v_rcp_f32 v11, v11
    v_mov_b32 v12, 0
    s_waitcnt vmcnt(0)
    v_fmac_f32 v12, v16, v80
    v_fmac_f32 v12, v17, v81
    v_fmac_f32 v12, v18, v82
    v_fmac_f32 v12, v19, v83
    v_fmac_f32 v12, v20, v84
    v_fmac_f32 v12, v21, v85
    v_fmac_f32 v12, v22, v86
    v_fmac_f32 v12, v23, v87
    v_fmac_f32 v12, v24, v88
    v_fmac_f32 v12, v25, v89
    v_fmac_f32 v12, v26, v90
    v_fmac_f32 v12, v27, v91
    v_fmac_f32 v12, v28, v92
    v_fmac_f32 v12, v29, v93
    v_fmac_f32 v12, v30, v94
    v_fmac_f32 v12, v31, v95
    v_fmac_f32 v12, v32, v96
    v_fmac_f32 v12, v33, v97
    v_fmac_f32 v12, v34, v98
    v_fmac_f32 v12, v35, v99
    v_fmac_f32 v12, v36, v100
    v_fmac_f32 v12, v37, v101
    v_fmac_f32 v12, v38, v102
    v_fmac_f32 v12, v39, v103
    v_fmac_f32 v12, v40, v104
    v_fmac_f32 v12, v41, v105
    v_fmac_f32 v12, v42, v106
    v_fmac_f32 v12, v43, v107
    v_fmac_f32 v12, v44, v108
    v_fmac_f32 v12, v45, v109
    v_fmac_f32 v12, v46, v110
    v_fmac_f32 v12, v47, v111
    v_mul_f32 v12, v12, v11
    v_lshlrev_b32 v1, 2, v1
    s_mov_b32 s18, 262144
    buffer_store_dword v12, v1, s[12:15], s18 offen
K4_END:
    s_endpgm
.section .rodata,"a"
.p2align 6
.amdhsa_kernel k4_comb_kernel
  .amdhsa_next_free_vgpr 132
  .amdhsa_next_free_sgpr 96
  .amdhsa_accum_offset 132
  .amdhsa_group_segment_fixed_size 0
  .amdhsa_kernarg_size 112
  .amdhsa_user_sgpr_count 2
  .amdhsa_user_sgpr_kernarg_segment_ptr 1
  .amdhsa_system_sgpr_workgroup_id_x 1
.end_amdhsa_kernel
.text
.globl k5_oproj_kernel
.p2align 8
.type k5_oproj_kernel,@function
k5_oproj_kernel:
    s_cmp_ge_u32 s2, 128
    s_cbranch_scc1 K5_END
    s_load_dwordx2 s[4:5], s[0:1], 32
    s_load_dwordx2 s[6:7], s[0:1], 80
    s_load_dwordx2 s[8:9], s[0:1], 104
    s_waitcnt lgkmcnt(0)
    s_lshr_b32 s3, s2, 6
    s_cmp_eq_u32 s3, 0
    s_cselect_b32 s4, s4, s6
    s_cselect_b32 s5, s5, s7
    s_mov_b32 s12, s4
    s_mov_b32 s13, s5
    s_mov_b32 s14, 0x400000
    s_mov_b32 s15, 0x00020000
    s_mov_b32 s16, s8
    s_mov_b32 s17, s9
    s_mov_b32 s18, 0x10000000
    s_mov_b32 s19, 0x00020000
    s_bfe_u32 s20, s2, 0x40002
    s_and_b32 s21, s2, 3
    v_lshrrev_b32 v1, 4, v0
    v_lshlrev_b32 v1, 10, v1
    v_and_b32 v2, 15, v0
    v_lshlrev_b32 v2, 4, v2
    v_add_u32 v1, v1, v2
    s_lshl_b32 s22, s20, 18
    s_lshl_b32 s23, s21, 8
    s_add_u32 s22, s22, s23
    v_add_u32 v1, s22, v1
    buffer_load_dwordx4 v[16:19], v1, s[12:15], 0 offen
    s_mov_b32 s22, 0x4000
    buffer_load_dwordx4 v[20:23], v1, s[12:15], s22 offen
    s_mov_b32 s22, 0x8000
    buffer_load_dwordx4 v[24:27], v1, s[12:15], s22 offen
    s_mov_b32 s22, 0xc000
    buffer_load_dwordx4 v[28:31], v1, s[12:15], s22 offen
    s_mov_b32 s22, 0x10000
    buffer_load_dwordx4 v[32:35], v1, s[12:15], s22 offen
    s_mov_b32 s22, 0x14000
    buffer_load_dwordx4 v[36:39], v1, s[12:15], s22 offen
    s_mov_b32 s22, 0x18000
    buffer_load_dwordx4 v[40:43], v1, s[12:15], s22 offen
    s_mov_b32 s22, 0x1c000
    buffer_load_dwordx4 v[44:47], v1, s[12:15], s22 offen
    s_mov_b32 s22, 0x20000
    buffer_load_dwordx4 v[48:51], v1, s[12:15], s22 offen
    s_mov_b32 s22, 0x24000
    buffer_load_dwordx4 v[52:55], v1, s[12:15], s22 offen
    s_mov_b32 s22, 0x28000
    buffer_load_dwordx4 v[56:59], v1, s[12:15], s22 offen
    s_mov_b32 s22, 0x2c000
    buffer_load_dwordx4 v[60:63], v1, s[12:15], s22 offen
    s_mov_b32 s22, 0x30000
    buffer_load_dwordx4 v[64:67], v1, s[12:15], s22 offen
    s_mov_b32 s22, 0x34000
    buffer_load_dwordx4 v[68:71], v1, s[12:15], s22 offen
    s_mov_b32 s22, 0x38000
    buffer_load_dwordx4 v[72:75], v1, s[12:15], s22 offen
    s_mov_b32 s22, 0x3c000
    buffer_load_dwordx4 v[76:79], v1, s[12:15], s22 offen
    v_lshlrev_b32 v2, 2, v0
    s_lshl_b32 s22, s20, 10
    s_cmp_eq_u32 s3, 0
    s_cbranch_scc0 K5_XB
    s_add_u32 s22, s22, 262144
    buffer_load_dword v8, v2, s[16:19], s22 offen
    s_add_u32 s22, s22, 16384
    buffer_load_dword v9, v2, s[16:19], s22 offen
    s_add_u32 s22, s22, 16384
    buffer_load_dword v10, v2, s[16:19], s22 offen
    s_add_u32 s22, s22, 16384
    buffer_load_dword v11, v2, s[16:19], s22 offen
    s_add_u32 s22, s22, 16384
    s_waitcnt vmcnt(0)
    s_branch K5_XDONE
K5_XB:
    s_add_u32 s22, s22, 327680
    buffer_load_dword v80, v2, s[16:19], s22 offen
    s_add_u32 s22, s22, 16384
    buffer_load_dword v81, v2, s[16:19], s22 offen
    s_add_u32 s22, s22, 16384
    buffer_load_dword v82, v2, s[16:19], s22 offen
    s_add_u32 s22, s22, 16384
    buffer_load_dword v83, v2, s[16:19], s22 offen
    s_add_u32 s22, s22, 16384
    buffer_load_dword v84, v2, s[16:19], s22 offen
    s_add_u32 s22, s22, 16384
    buffer_load_dword v85, v2, s[16:19], s22 offen
    s_add_u32 s22, s22, 16384
    buffer_load_dword v86, v2, s[16:19], s22 offen
    s_add_u32 s22, s22, 16384
    buffer_load_dword v87, v2, s[16:19], s22 offen
    s_add_u32 s22, s22, 16384
    buffer_load_dword v88, v2, s[16:19], s22 offen
    s_add_u32 s22, s22, 16384
    buffer_load_dword v89, v2, s[16:19], s22 offen
    s_add_u32 s22, s22, 16384
    buffer_load_dword v90, v2, s[16:19], s22 offen
    s_add_u32 s22, s22, 16384
    buffer_load_dword v91, v2, s[16:19], s22 offen
    s_add_u32 s22, s22, 16384
    buffer_load_dword v92, v2, s[16:19], s22 offen
    s_add_u32 s22, s22, 16384
    buffer_load_dword v93, v2, s[16:19], s22 offen
    s_add_u32 s22, s22, 16384
    buffer_load_dword v94, v2, s[16:19], s22 offen
    s_add_u32 s22, s22, 16384
    buffer_load_dword v95, v2, s[16:19], s22 offen
    s_add_u32 s22, s22, 16384
    buffer_load_dword v96, v2, s[16:19], s22 offen
    s_add_u32 s22, s22, 16384
    buffer_load_dword v97, v2, s[16:19], s22 offen
    s_add_u32 s22, s22, 16384
    buffer_load_dword v98, v2, s[16:19], s22 offen
    s_add_u32 s22, s22, 16384
    buffer_load_dword v99, v2, s[16:19], s22 offen
    s_add_u32 s22, s22, 16384
    buffer_load_dword v100, v2, s[16:19], s22 offen
    s_add_u32 s22, s22, 16384
    buffer_load_dword v101, v2, s[16:19], s22 offen
    s_add_u32 s22, s22, 16384
    buffer_load_dword v102, v2, s[16:19], s22 offen
    s_add_u32 s22, s22, 16384
    buffer_load_dword v103, v2, s[16:19], s22 offen
    s_add_u32 s22, s22, 16384
    buffer_load_dword v104, v2, s[16:19], s22 offen
    s_add_u32 s22, s22, 16384
    buffer_load_dword v105, v2, s[16:19], s22 offen
    s_add_u32 s22, s22, 16384
    buffer_load_dword v106, v2, s[16:19], s22 offen
    s_add_u32 s22, s22, 16384
    buffer_load_dword v107, v2, s[16:19], s22 offen
    s_add_u32 s22, s22, 16384
    buffer_load_dword v108, v2, s[16:19], s22 offen
    s_add_u32 s22, s22, 16384
    buffer_load_dword v109, v2, s[16:19], s22 offen
    s_add_u32 s22, s22, 16384
    buffer_load_dword v110, v2, s[16:19], s22 offen
    s_add_u32 s22, s22, 16384
    buffer_load_dword v111, v2, s[16:19], s22 offen
    s_add_u32 s22, s22, 16384
    s_waitcnt vmcnt(0)
    v_add_f32 v8, v80, v84
    v_add_f32 v8, v8, v88
    v_add_f32 v8, v8, v92
    v_add_f32 v8, v8, v96
    v_add_f32 v8, v8, v100
    v_add_f32 v8, v8, v104
    v_add_f32 v8, v8, v108
    v_add_f32 v9, v81, v85
    v_add_f32 v9, v9, v89
    v_add_f32 v9, v9, v93
    v_add_f32 v9, v9, v97
    v_add_f32 v9, v9, v101
    v_add_f32 v9, v9, v105
    v_add_f32 v9, v9, v109
    v_add_f32 v10, v82, v86
    v_add_f32 v10, v10, v90
    v_add_f32 v10, v10, v94
    v_add_f32 v10, v10, v98
    v_add_f32 v10, v10, v102
    v_add_f32 v10, v10, v106
    v_add_f32 v10, v10, v110
    v_add_f32 v11, v83, v87
    v_add_f32 v11, v11, v91
    v_add_f32 v11, v11, v95
    v_add_f32 v11, v11, v99
    v_add_f32 v11, v11, v103
    v_add_f32 v11, v11, v107
    v_add_f32 v11, v11, v111
K5_XDONE:
    v_lshlrev_b32 v2, 4, v0
    ds_write_b128 v2, v[8:11] offset:0
    s_waitcnt lgkmcnt(0)
    s_barrier
    v_lshrrev_b32 v176, 4, v0
    v_lshlrev_b32 v177, 4, v176
    ds_read_b128 v[80:83], v177 offset:0
    ds_read_b128 v[84:87], v177 offset:256
    ds_read_b128 v[88:91], v177 offset:512
    ds_read_b128 v[92:95], v177 offset:768
    ds_read_b128 v[96:99], v177 offset:1024
    ds_read_b128 v[100:103], v177 offset:1280
    ds_read_b128 v[104:107], v177 offset:1536
    ds_read_b128 v[108:111], v177 offset:1792
    ds_read_b128 v[112:115], v177 offset:2048
    ds_read_b128 v[116:119], v177 offset:2304
    ds_read_b128 v[120:123], v177 offset:2560
    ds_read_b128 v[124:127], v177 offset:2816
    ds_read_b128 v[128:131], v177 offset:3072
    ds_read_b128 v[132:135], v177 offset:3328
    ds_read_b128 v[136:139], v177 offset:3584
    ds_read_b128 v[140:143], v177 offset:3840
    v_mov_b32 v144, 0
    v_mov_b32 v145, 0
    v_mov_b32 v146, 0
    v_mov_b32 v147, 0
    v_mov_b32 v148, 0
    v_mov_b32 v149, 0
    v_mov_b32 v150, 0
    v_mov_b32 v151, 0
    v_mov_b32 v152, 0
    v_mov_b32 v153, 0
    v_mov_b32 v154, 0
    v_mov_b32 v155, 0
    v_mov_b32 v156, 0
    v_mov_b32 v157, 0
    v_mov_b32 v158, 0
    v_mov_b32 v159, 0
    v_mov_b32 v160, 0
    v_mov_b32 v161, 0
    v_mov_b32 v162, 0
    v_mov_b32 v163, 0
    v_mov_b32 v164, 0
    v_mov_b32 v165, 0
    v_mov_b32 v166, 0
    v_mov_b32 v167, 0
    v_mov_b32 v168, 0
    v_mov_b32 v169, 0
    v_mov_b32 v170, 0
    v_mov_b32 v171, 0
    v_mov_b32 v172, 0
    v_mov_b32 v173, 0
    v_mov_b32 v174, 0
    v_mov_b32 v175, 0
    s_waitcnt lgkmcnt(0)
    s_waitcnt vmcnt(15)
    v_lshlrev_b32 v178, 16, v16
    v_and_b32 v179, 0xffff0000, v16
    v_fmac_f32 v144, v80, v178
    v_fmac_f32 v145, v80, v179
    v_fmac_f32 v152, v81, v178
    v_fmac_f32 v153, v81, v179
    v_fmac_f32 v160, v82, v178
    v_fmac_f32 v161, v82, v179
    v_fmac_f32 v168, v83, v178
    v_fmac_f32 v169, v83, v179
    v_lshlrev_b32 v178, 16, v17
    v_and_b32 v179, 0xffff0000, v17
    v_fmac_f32 v146, v80, v178
    v_fmac_f32 v147, v80, v179
    v_fmac_f32 v154, v81, v178
    v_fmac_f32 v155, v81, v179
    v_fmac_f32 v162, v82, v178
    v_fmac_f32 v163, v82, v179
    v_fmac_f32 v170, v83, v178
    v_fmac_f32 v171, v83, v179
    v_lshlrev_b32 v178, 16, v18
    v_and_b32 v179, 0xffff0000, v18
    v_fmac_f32 v148, v80, v178
    v_fmac_f32 v149, v80, v179
    v_fmac_f32 v156, v81, v178
    v_fmac_f32 v157, v81, v179
    v_fmac_f32 v164, v82, v178
    v_fmac_f32 v165, v82, v179
    v_fmac_f32 v172, v83, v178
    v_fmac_f32 v173, v83, v179
    v_lshlrev_b32 v178, 16, v19
    v_and_b32 v179, 0xffff0000, v19
    v_fmac_f32 v150, v80, v178
    v_fmac_f32 v151, v80, v179
    v_fmac_f32 v158, v81, v178
    v_fmac_f32 v159, v81, v179
    v_fmac_f32 v166, v82, v178
    v_fmac_f32 v167, v82, v179
    v_fmac_f32 v174, v83, v178
    v_fmac_f32 v175, v83, v179
    s_waitcnt vmcnt(14)
    v_lshlrev_b32 v178, 16, v20
    v_and_b32 v179, 0xffff0000, v20
    v_fmac_f32 v144, v84, v178
    v_fmac_f32 v145, v84, v179
    v_fmac_f32 v152, v85, v178
    v_fmac_f32 v153, v85, v179
    v_fmac_f32 v160, v86, v178
    v_fmac_f32 v161, v86, v179
    v_fmac_f32 v168, v87, v178
    v_fmac_f32 v169, v87, v179
    v_lshlrev_b32 v178, 16, v21
    v_and_b32 v179, 0xffff0000, v21
    v_fmac_f32 v146, v84, v178
    v_fmac_f32 v147, v84, v179
    v_fmac_f32 v154, v85, v178
    v_fmac_f32 v155, v85, v179
    v_fmac_f32 v162, v86, v178
    v_fmac_f32 v163, v86, v179
    v_fmac_f32 v170, v87, v178
    v_fmac_f32 v171, v87, v179
    v_lshlrev_b32 v178, 16, v22
    v_and_b32 v179, 0xffff0000, v22
    v_fmac_f32 v148, v84, v178
    v_fmac_f32 v149, v84, v179
    v_fmac_f32 v156, v85, v178
    v_fmac_f32 v157, v85, v179
    v_fmac_f32 v164, v86, v178
    v_fmac_f32 v165, v86, v179
    v_fmac_f32 v172, v87, v178
    v_fmac_f32 v173, v87, v179
    v_lshlrev_b32 v178, 16, v23
    v_and_b32 v179, 0xffff0000, v23
    v_fmac_f32 v150, v84, v178
    v_fmac_f32 v151, v84, v179
    v_fmac_f32 v158, v85, v178
    v_fmac_f32 v159, v85, v179
    v_fmac_f32 v166, v86, v178
    v_fmac_f32 v167, v86, v179
    v_fmac_f32 v174, v87, v178
    v_fmac_f32 v175, v87, v179
    s_waitcnt vmcnt(13)
    v_lshlrev_b32 v178, 16, v24
    v_and_b32 v179, 0xffff0000, v24
    v_fmac_f32 v144, v88, v178
    v_fmac_f32 v145, v88, v179
    v_fmac_f32 v152, v89, v178
    v_fmac_f32 v153, v89, v179
    v_fmac_f32 v160, v90, v178
    v_fmac_f32 v161, v90, v179
    v_fmac_f32 v168, v91, v178
    v_fmac_f32 v169, v91, v179
    v_lshlrev_b32 v178, 16, v25
    v_and_b32 v179, 0xffff0000, v25
    v_fmac_f32 v146, v88, v178
    v_fmac_f32 v147, v88, v179
    v_fmac_f32 v154, v89, v178
    v_fmac_f32 v155, v89, v179
    v_fmac_f32 v162, v90, v178
    v_fmac_f32 v163, v90, v179
    v_fmac_f32 v170, v91, v178
    v_fmac_f32 v171, v91, v179
    v_lshlrev_b32 v178, 16, v26
    v_and_b32 v179, 0xffff0000, v26
    v_fmac_f32 v148, v88, v178
    v_fmac_f32 v149, v88, v179
    v_fmac_f32 v156, v89, v178
    v_fmac_f32 v157, v89, v179
    v_fmac_f32 v164, v90, v178
    v_fmac_f32 v165, v90, v179
    v_fmac_f32 v172, v91, v178
    v_fmac_f32 v173, v91, v179
    v_lshlrev_b32 v178, 16, v27
    v_and_b32 v179, 0xffff0000, v27
    v_fmac_f32 v150, v88, v178
    v_fmac_f32 v151, v88, v179
    v_fmac_f32 v158, v89, v178
    v_fmac_f32 v159, v89, v179
    v_fmac_f32 v166, v90, v178
    v_fmac_f32 v167, v90, v179
    v_fmac_f32 v174, v91, v178
    v_fmac_f32 v175, v91, v179
    s_waitcnt vmcnt(12)
    v_lshlrev_b32 v178, 16, v28
    v_and_b32 v179, 0xffff0000, v28
    v_fmac_f32 v144, v92, v178
    v_fmac_f32 v145, v92, v179
    v_fmac_f32 v152, v93, v178
    v_fmac_f32 v153, v93, v179
    v_fmac_f32 v160, v94, v178
    v_fmac_f32 v161, v94, v179
    v_fmac_f32 v168, v95, v178
    v_fmac_f32 v169, v95, v179
    v_lshlrev_b32 v178, 16, v29
    v_and_b32 v179, 0xffff0000, v29
    v_fmac_f32 v146, v92, v178
    v_fmac_f32 v147, v92, v179
    v_fmac_f32 v154, v93, v178
    v_fmac_f32 v155, v93, v179
    v_fmac_f32 v162, v94, v178
    v_fmac_f32 v163, v94, v179
    v_fmac_f32 v170, v95, v178
    v_fmac_f32 v171, v95, v179
    v_lshlrev_b32 v178, 16, v30
    v_and_b32 v179, 0xffff0000, v30
    v_fmac_f32 v148, v92, v178
    v_fmac_f32 v149, v92, v179
    v_fmac_f32 v156, v93, v178
    v_fmac_f32 v157, v93, v179
    v_fmac_f32 v164, v94, v178
    v_fmac_f32 v165, v94, v179
    v_fmac_f32 v172, v95, v178
    v_fmac_f32 v173, v95, v179
    v_lshlrev_b32 v178, 16, v31
    v_and_b32 v179, 0xffff0000, v31
    v_fmac_f32 v150, v92, v178
    v_fmac_f32 v151, v92, v179
    v_fmac_f32 v158, v93, v178
    v_fmac_f32 v159, v93, v179
    v_fmac_f32 v166, v94, v178
    v_fmac_f32 v167, v94, v179
    v_fmac_f32 v174, v95, v178
    v_fmac_f32 v175, v95, v179
    s_waitcnt vmcnt(11)
    v_lshlrev_b32 v178, 16, v32
    v_and_b32 v179, 0xffff0000, v32
    v_fmac_f32 v144, v96, v178
    v_fmac_f32 v145, v96, v179
    v_fmac_f32 v152, v97, v178
    v_fmac_f32 v153, v97, v179
    v_fmac_f32 v160, v98, v178
    v_fmac_f32 v161, v98, v179
    v_fmac_f32 v168, v99, v178
    v_fmac_f32 v169, v99, v179
    v_lshlrev_b32 v178, 16, v33
    v_and_b32 v179, 0xffff0000, v33
    v_fmac_f32 v146, v96, v178
    v_fmac_f32 v147, v96, v179
    v_fmac_f32 v154, v97, v178
    v_fmac_f32 v155, v97, v179
    v_fmac_f32 v162, v98, v178
    v_fmac_f32 v163, v98, v179
    v_fmac_f32 v170, v99, v178
    v_fmac_f32 v171, v99, v179
    v_lshlrev_b32 v178, 16, v34
    v_and_b32 v179, 0xffff0000, v34
    v_fmac_f32 v148, v96, v178
    v_fmac_f32 v149, v96, v179
    v_fmac_f32 v156, v97, v178
    v_fmac_f32 v157, v97, v179
    v_fmac_f32 v164, v98, v178
    v_fmac_f32 v165, v98, v179
    v_fmac_f32 v172, v99, v178
    v_fmac_f32 v173, v99, v179
    v_lshlrev_b32 v178, 16, v35
    v_and_b32 v179, 0xffff0000, v35
    v_fmac_f32 v150, v96, v178
    v_fmac_f32 v151, v96, v179
    v_fmac_f32 v158, v97, v178
    v_fmac_f32 v159, v97, v179
    v_fmac_f32 v166, v98, v178
    v_fmac_f32 v167, v98, v179
    v_fmac_f32 v174, v99, v178
    v_fmac_f32 v175, v99, v179
    s_waitcnt vmcnt(10)
    v_lshlrev_b32 v178, 16, v36
    v_and_b32 v179, 0xffff0000, v36
    v_fmac_f32 v144, v100, v178
    v_fmac_f32 v145, v100, v179
    v_fmac_f32 v152, v101, v178
    v_fmac_f32 v153, v101, v179
    v_fmac_f32 v160, v102, v178
    v_fmac_f32 v161, v102, v179
    v_fmac_f32 v168, v103, v178
    v_fmac_f32 v169, v103, v179
    v_lshlrev_b32 v178, 16, v37
    v_and_b32 v179, 0xffff0000, v37
    v_fmac_f32 v146, v100, v178
    v_fmac_f32 v147, v100, v179
    v_fmac_f32 v154, v101, v178
    v_fmac_f32 v155, v101, v179
    v_fmac_f32 v162, v102, v178
    v_fmac_f32 v163, v102, v179
    v_fmac_f32 v170, v103, v178
    v_fmac_f32 v171, v103, v179
    v_lshlrev_b32 v178, 16, v38
    v_and_b32 v179, 0xffff0000, v38
    v_fmac_f32 v148, v100, v178
    v_fmac_f32 v149, v100, v179
    v_fmac_f32 v156, v101, v178
    v_fmac_f32 v157, v101, v179
    v_fmac_f32 v164, v102, v178
    v_fmac_f32 v165, v102, v179
    v_fmac_f32 v172, v103, v178
    v_fmac_f32 v173, v103, v179
    v_lshlrev_b32 v178, 16, v39
    v_and_b32 v179, 0xffff0000, v39
    v_fmac_f32 v150, v100, v178
    v_fmac_f32 v151, v100, v179
    v_fmac_f32 v158, v101, v178
    v_fmac_f32 v159, v101, v179
    v_fmac_f32 v166, v102, v178
    v_fmac_f32 v167, v102, v179
    v_fmac_f32 v174, v103, v178
    v_fmac_f32 v175, v103, v179
    s_waitcnt vmcnt(9)
    v_lshlrev_b32 v178, 16, v40
    v_and_b32 v179, 0xffff0000, v40
    v_fmac_f32 v144, v104, v178
    v_fmac_f32 v145, v104, v179
    v_fmac_f32 v152, v105, v178
    v_fmac_f32 v153, v105, v179
    v_fmac_f32 v160, v106, v178
    v_fmac_f32 v161, v106, v179
    v_fmac_f32 v168, v107, v178
    v_fmac_f32 v169, v107, v179
    v_lshlrev_b32 v178, 16, v41
    v_and_b32 v179, 0xffff0000, v41
    v_fmac_f32 v146, v104, v178
    v_fmac_f32 v147, v104, v179
    v_fmac_f32 v154, v105, v178
    v_fmac_f32 v155, v105, v179
    v_fmac_f32 v162, v106, v178
    v_fmac_f32 v163, v106, v179
    v_fmac_f32 v170, v107, v178
    v_fmac_f32 v171, v107, v179
    v_lshlrev_b32 v178, 16, v42
    v_and_b32 v179, 0xffff0000, v42
    v_fmac_f32 v148, v104, v178
    v_fmac_f32 v149, v104, v179
    v_fmac_f32 v156, v105, v178
    v_fmac_f32 v157, v105, v179
    v_fmac_f32 v164, v106, v178
    v_fmac_f32 v165, v106, v179
    v_fmac_f32 v172, v107, v178
    v_fmac_f32 v173, v107, v179
    v_lshlrev_b32 v178, 16, v43
    v_and_b32 v179, 0xffff0000, v43
    v_fmac_f32 v150, v104, v178
    v_fmac_f32 v151, v104, v179
    v_fmac_f32 v158, v105, v178
    v_fmac_f32 v159, v105, v179
    v_fmac_f32 v166, v106, v178
    v_fmac_f32 v167, v106, v179
    v_fmac_f32 v174, v107, v178
    v_fmac_f32 v175, v107, v179
    s_waitcnt vmcnt(8)
    v_lshlrev_b32 v178, 16, v44
    v_and_b32 v179, 0xffff0000, v44
    v_fmac_f32 v144, v108, v178
    v_fmac_f32 v145, v108, v179
    v_fmac_f32 v152, v109, v178
    v_fmac_f32 v153, v109, v179
    v_fmac_f32 v160, v110, v178
    v_fmac_f32 v161, v110, v179
    v_fmac_f32 v168, v111, v178
    v_fmac_f32 v169, v111, v179
    v_lshlrev_b32 v178, 16, v45
    v_and_b32 v179, 0xffff0000, v45
    v_fmac_f32 v146, v108, v178
    v_fmac_f32 v147, v108, v179
    v_fmac_f32 v154, v109, v178
    v_fmac_f32 v155, v109, v179
    v_fmac_f32 v162, v110, v178
    v_fmac_f32 v163, v110, v179
    v_fmac_f32 v170, v111, v178
    v_fmac_f32 v171, v111, v179
    v_lshlrev_b32 v178, 16, v46
    v_and_b32 v179, 0xffff0000, v46
    v_fmac_f32 v148, v108, v178
    v_fmac_f32 v149, v108, v179
    v_fmac_f32 v156, v109, v178
    v_fmac_f32 v157, v109, v179
    v_fmac_f32 v164, v110, v178
    v_fmac_f32 v165, v110, v179
    v_fmac_f32 v172, v111, v178
    v_fmac_f32 v173, v111, v179
    v_lshlrev_b32 v178, 16, v47
    v_and_b32 v179, 0xffff0000, v47
    v_fmac_f32 v150, v108, v178
    v_fmac_f32 v151, v108, v179
    v_fmac_f32 v158, v109, v178
    v_fmac_f32 v159, v109, v179
    v_fmac_f32 v166, v110, v178
    v_fmac_f32 v167, v110, v179
    v_fmac_f32 v174, v111, v178
    v_fmac_f32 v175, v111, v179
    s_waitcnt vmcnt(7)
    v_lshlrev_b32 v178, 16, v48
    v_and_b32 v179, 0xffff0000, v48
    v_fmac_f32 v144, v112, v178
    v_fmac_f32 v145, v112, v179
    v_fmac_f32 v152, v113, v178
    v_fmac_f32 v153, v113, v179
    v_fmac_f32 v160, v114, v178
    v_fmac_f32 v161, v114, v179
    v_fmac_f32 v168, v115, v178
    v_fmac_f32 v169, v115, v179
    v_lshlrev_b32 v178, 16, v49
    v_and_b32 v179, 0xffff0000, v49
    v_fmac_f32 v146, v112, v178
    v_fmac_f32 v147, v112, v179
    v_fmac_f32 v154, v113, v178
    v_fmac_f32 v155, v113, v179
    v_fmac_f32 v162, v114, v178
    v_fmac_f32 v163, v114, v179
    v_fmac_f32 v170, v115, v178
    v_fmac_f32 v171, v115, v179
    v_lshlrev_b32 v178, 16, v50
    v_and_b32 v179, 0xffff0000, v50
    v_fmac_f32 v148, v112, v178
    v_fmac_f32 v149, v112, v179
    v_fmac_f32 v156, v113, v178
    v_fmac_f32 v157, v113, v179
    v_fmac_f32 v164, v114, v178
    v_fmac_f32 v165, v114, v179
    v_fmac_f32 v172, v115, v178
    v_fmac_f32 v173, v115, v179
    v_lshlrev_b32 v178, 16, v51
    v_and_b32 v179, 0xffff0000, v51
    v_fmac_f32 v150, v112, v178
    v_fmac_f32 v151, v112, v179
    v_fmac_f32 v158, v113, v178
    v_fmac_f32 v159, v113, v179
    v_fmac_f32 v166, v114, v178
    v_fmac_f32 v167, v114, v179
    v_fmac_f32 v174, v115, v178
    v_fmac_f32 v175, v115, v179
    s_waitcnt vmcnt(6)
    v_lshlrev_b32 v178, 16, v52
    v_and_b32 v179, 0xffff0000, v52
    v_fmac_f32 v144, v116, v178
    v_fmac_f32 v145, v116, v179
    v_fmac_f32 v152, v117, v178
    v_fmac_f32 v153, v117, v179
    v_fmac_f32 v160, v118, v178
    v_fmac_f32 v161, v118, v179
    v_fmac_f32 v168, v119, v178
    v_fmac_f32 v169, v119, v179
    v_lshlrev_b32 v178, 16, v53
    v_and_b32 v179, 0xffff0000, v53
    v_fmac_f32 v146, v116, v178
    v_fmac_f32 v147, v116, v179
    v_fmac_f32 v154, v117, v178
    v_fmac_f32 v155, v117, v179
    v_fmac_f32 v162, v118, v178
    v_fmac_f32 v163, v118, v179
    v_fmac_f32 v170, v119, v178
    v_fmac_f32 v171, v119, v179
    v_lshlrev_b32 v178, 16, v54
    v_and_b32 v179, 0xffff0000, v54
    v_fmac_f32 v148, v116, v178
    v_fmac_f32 v149, v116, v179
    v_fmac_f32 v156, v117, v178
    v_fmac_f32 v157, v117, v179
    v_fmac_f32 v164, v118, v178
    v_fmac_f32 v165, v118, v179
    v_fmac_f32 v172, v119, v178
    v_fmac_f32 v173, v119, v179
    v_lshlrev_b32 v178, 16, v55
    v_and_b32 v179, 0xffff0000, v55
    v_fmac_f32 v150, v116, v178
    v_fmac_f32 v151, v116, v179
    v_fmac_f32 v158, v117, v178
    v_fmac_f32 v159, v117, v179
    v_fmac_f32 v166, v118, v178
    v_fmac_f32 v167, v118, v179
    v_fmac_f32 v174, v119, v178
    v_fmac_f32 v175, v119, v179
    s_waitcnt vmcnt(5)
    v_lshlrev_b32 v178, 16, v56
    v_and_b32 v179, 0xffff0000, v56
    v_fmac_f32 v144, v120, v178
    v_fmac_f32 v145, v120, v179
    v_fmac_f32 v152, v121, v178
    v_fmac_f32 v153, v121, v179
    v_fmac_f32 v160, v122, v178
    v_fmac_f32 v161, v122, v179
    v_fmac_f32 v168, v123, v178
    v_fmac_f32 v169, v123, v179
    v_lshlrev_b32 v178, 16, v57
    v_and_b32 v179, 0xffff0000, v57
    v_fmac_f32 v146, v120, v178
    v_fmac_f32 v147, v120, v179
    v_fmac_f32 v154, v121, v178
    v_fmac_f32 v155, v121, v179
    v_fmac_f32 v162, v122, v178
    v_fmac_f32 v163, v122, v179
    v_fmac_f32 v170, v123, v178
    v_fmac_f32 v171, v123, v179
    v_lshlrev_b32 v178, 16, v58
    v_and_b32 v179, 0xffff0000, v58
    v_fmac_f32 v148, v120, v178
    v_fmac_f32 v149, v120, v179
    v_fmac_f32 v156, v121, v178
    v_fmac_f32 v157, v121, v179
    v_fmac_f32 v164, v122, v178
    v_fmac_f32 v165, v122, v179
    v_fmac_f32 v172, v123, v178
    v_fmac_f32 v173, v123, v179
    v_lshlrev_b32 v178, 16, v59
    v_and_b32 v179, 0xffff0000, v59
    v_fmac_f32 v150, v120, v178
    v_fmac_f32 v151, v120, v179
    v_fmac_f32 v158, v121, v178
    v_fmac_f32 v159, v121, v179
    v_fmac_f32 v166, v122, v178
    v_fmac_f32 v167, v122, v179
    v_fmac_f32 v174, v123, v178
    v_fmac_f32 v175, v123, v179
    s_waitcnt vmcnt(4)
    v_lshlrev_b32 v178, 16, v60
    v_and_b32 v179, 0xffff0000, v60
    v_fmac_f32 v144, v124, v178
    v_fmac_f32 v145, v124, v179
    v_fmac_f32 v152, v125, v178
    v_fmac_f32 v153, v125, v179
    v_fmac_f32 v160, v126, v178
    v_fmac_f32 v161, v126, v179
    v_fmac_f32 v168, v127, v178
    v_fmac_f32 v169, v127, v179
    v_lshlrev_b32 v178, 16, v61
    v_and_b32 v179, 0xffff0000, v61
    v_fmac_f32 v146, v124, v178
    v_fmac_f32 v147, v124, v179
    v_fmac_f32 v154, v125, v178
    v_fmac_f32 v155, v125, v179
    v_fmac_f32 v162, v126, v178
    v_fmac_f32 v163, v126, v179
    v_fmac_f32 v170, v127, v178
    v_fmac_f32 v171, v127, v179
    v_lshlrev_b32 v178, 16, v62
    v_and_b32 v179, 0xffff0000, v62
    v_fmac_f32 v148, v124, v178
    v_fmac_f32 v149, v124, v179
    v_fmac_f32 v156, v125, v178
    v_fmac_f32 v157, v125, v179
    v_fmac_f32 v164, v126, v178
    v_fmac_f32 v165, v126, v179
    v_fmac_f32 v172, v127, v178
    v_fmac_f32 v173, v127, v179
    v_lshlrev_b32 v178, 16, v63
    v_and_b32 v179, 0xffff0000, v63
    v_fmac_f32 v150, v124, v178
    v_fmac_f32 v151, v124, v179
    v_fmac_f32 v158, v125, v178
    v_fmac_f32 v159, v125, v179
    v_fmac_f32 v166, v126, v178
    v_fmac_f32 v167, v126, v179
    v_fmac_f32 v174, v127, v178
    v_fmac_f32 v175, v127, v179
    s_waitcnt vmcnt(3)
    v_lshlrev_b32 v178, 16, v64
    v_and_b32 v179, 0xffff0000, v64
    v_fmac_f32 v144, v128, v178
    v_fmac_f32 v145, v128, v179
    v_fmac_f32 v152, v129, v178
    v_fmac_f32 v153, v129, v179
    v_fmac_f32 v160, v130, v178
    v_fmac_f32 v161, v130, v179
    v_fmac_f32 v168, v131, v178
    v_fmac_f32 v169, v131, v179
    v_lshlrev_b32 v178, 16, v65
    v_and_b32 v179, 0xffff0000, v65
    v_fmac_f32 v146, v128, v178
    v_fmac_f32 v147, v128, v179
    v_fmac_f32 v154, v129, v178
    v_fmac_f32 v155, v129, v179
    v_fmac_f32 v162, v130, v178
    v_fmac_f32 v163, v130, v179
    v_fmac_f32 v170, v131, v178
    v_fmac_f32 v171, v131, v179
    v_lshlrev_b32 v178, 16, v66
    v_and_b32 v179, 0xffff0000, v66
    v_fmac_f32 v148, v128, v178
    v_fmac_f32 v149, v128, v179
    v_fmac_f32 v156, v129, v178
    v_fmac_f32 v157, v129, v179
    v_fmac_f32 v164, v130, v178
    v_fmac_f32 v165, v130, v179
    v_fmac_f32 v172, v131, v178
    v_fmac_f32 v173, v131, v179
    v_lshlrev_b32 v178, 16, v67
    v_and_b32 v179, 0xffff0000, v67
    v_fmac_f32 v150, v128, v178
    v_fmac_f32 v151, v128, v179
    v_fmac_f32 v158, v129, v178
    v_fmac_f32 v159, v129, v179
    v_fmac_f32 v166, v130, v178
    v_fmac_f32 v167, v130, v179
    v_fmac_f32 v174, v131, v178
    v_fmac_f32 v175, v131, v179
    s_waitcnt vmcnt(2)
    v_lshlrev_b32 v178, 16, v68
    v_and_b32 v179, 0xffff0000, v68
    v_fmac_f32 v144, v132, v178
    v_fmac_f32 v145, v132, v179
    v_fmac_f32 v152, v133, v178
    v_fmac_f32 v153, v133, v179
    v_fmac_f32 v160, v134, v178
    v_fmac_f32 v161, v134, v179
    v_fmac_f32 v168, v135, v178
    v_fmac_f32 v169, v135, v179
    v_lshlrev_b32 v178, 16, v69
    v_and_b32 v179, 0xffff0000, v69
    v_fmac_f32 v146, v132, v178
    v_fmac_f32 v147, v132, v179
    v_fmac_f32 v154, v133, v178
    v_fmac_f32 v155, v133, v179
    v_fmac_f32 v162, v134, v178
    v_fmac_f32 v163, v134, v179
    v_fmac_f32 v170, v135, v178
    v_fmac_f32 v171, v135, v179
    v_lshlrev_b32 v178, 16, v70
    v_and_b32 v179, 0xffff0000, v70
    v_fmac_f32 v148, v132, v178
    v_fmac_f32 v149, v132, v179
    v_fmac_f32 v156, v133, v178
    v_fmac_f32 v157, v133, v179
    v_fmac_f32 v164, v134, v178
    v_fmac_f32 v165, v134, v179
    v_fmac_f32 v172, v135, v178
    v_fmac_f32 v173, v135, v179
    v_lshlrev_b32 v178, 16, v71
    v_and_b32 v179, 0xffff0000, v71
    v_fmac_f32 v150, v132, v178
    v_fmac_f32 v151, v132, v179
    v_fmac_f32 v158, v133, v178
    v_fmac_f32 v159, v133, v179
    v_fmac_f32 v166, v134, v178
    v_fmac_f32 v167, v134, v179
    v_fmac_f32 v174, v135, v178
    v_fmac_f32 v175, v135, v179
    s_waitcnt vmcnt(1)
    v_lshlrev_b32 v178, 16, v72
    v_and_b32 v179, 0xffff0000, v72
    v_fmac_f32 v144, v136, v178
    v_fmac_f32 v145, v136, v179
    v_fmac_f32 v152, v137, v178
    v_fmac_f32 v153, v137, v179
    v_fmac_f32 v160, v138, v178
    v_fmac_f32 v161, v138, v179
    v_fmac_f32 v168, v139, v178
    v_fmac_f32 v169, v139, v179
    v_lshlrev_b32 v178, 16, v73
    v_and_b32 v179, 0xffff0000, v73
    v_fmac_f32 v146, v136, v178
    v_fmac_f32 v147, v136, v179
    v_fmac_f32 v154, v137, v178
    v_fmac_f32 v155, v137, v179
    v_fmac_f32 v162, v138, v178
    v_fmac_f32 v163, v138, v179
    v_fmac_f32 v170, v139, v178
    v_fmac_f32 v171, v139, v179
    v_lshlrev_b32 v178, 16, v74
    v_and_b32 v179, 0xffff0000, v74
    v_fmac_f32 v148, v136, v178
    v_fmac_f32 v149, v136, v179
    v_fmac_f32 v156, v137, v178
    v_fmac_f32 v157, v137, v179
    v_fmac_f32 v164, v138, v178
    v_fmac_f32 v165, v138, v179
    v_fmac_f32 v172, v139, v178
    v_fmac_f32 v173, v139, v179
    v_lshlrev_b32 v178, 16, v75
    v_and_b32 v179, 0xffff0000, v75
    v_fmac_f32 v150, v136, v178
    v_fmac_f32 v151, v136, v179
    v_fmac_f32 v158, v137, v178
    v_fmac_f32 v159, v137, v179
    v_fmac_f32 v166, v138, v178
    v_fmac_f32 v167, v138, v179
    v_fmac_f32 v174, v139, v178
    v_fmac_f32 v175, v139, v179
    s_waitcnt vmcnt(0)
    v_lshlrev_b32 v178, 16, v76
    v_and_b32 v179, 0xffff0000, v76
    v_fmac_f32 v144, v140, v178
    v_fmac_f32 v145, v140, v179
    v_fmac_f32 v152, v141, v178
    v_fmac_f32 v153, v141, v179
    v_fmac_f32 v160, v142, v178
    v_fmac_f32 v161, v142, v179
    v_fmac_f32 v168, v143, v178
    v_fmac_f32 v169, v143, v179
    v_lshlrev_b32 v178, 16, v77
    v_and_b32 v179, 0xffff0000, v77
    v_fmac_f32 v146, v140, v178
    v_fmac_f32 v147, v140, v179
    v_fmac_f32 v154, v141, v178
    v_fmac_f32 v155, v141, v179
    v_fmac_f32 v162, v142, v178
    v_fmac_f32 v163, v142, v179
    v_fmac_f32 v170, v143, v178
    v_fmac_f32 v171, v143, v179
    v_lshlrev_b32 v178, 16, v78
    v_and_b32 v179, 0xffff0000, v78
    v_fmac_f32 v148, v140, v178
    v_fmac_f32 v149, v140, v179
    v_fmac_f32 v156, v141, v178
    v_fmac_f32 v157, v141, v179
    v_fmac_f32 v164, v142, v178
    v_fmac_f32 v165, v142, v179
    v_fmac_f32 v172, v143, v178
    v_fmac_f32 v173, v143, v179
    v_lshlrev_b32 v178, 16, v79
    v_and_b32 v179, 0xffff0000, v79
    v_fmac_f32 v150, v140, v178
    v_fmac_f32 v151, v140, v179
    v_fmac_f32 v158, v141, v178
    v_fmac_f32 v159, v141, v179
    v_fmac_f32 v166, v142, v178
    v_fmac_f32 v167, v142, v179
    v_fmac_f32 v174, v143, v178
    v_fmac_f32 v175, v143, v179
    v_and_b32 v177, 15, v0
    v_lshlrev_b32 v177, 5, v177
    v_mul_u32_u24 v178, 2048, v176
    v_add_u32 v177, v177, v178
    ds_write_b128 v177, v[144:147] offset:4096
    ds_write_b128 v177, v[148:151] offset:4112
    ds_write_b128 v177, v[152:155] offset:4608
    ds_write_b128 v177, v[156:159] offset:4624
    ds_write_b128 v177, v[160:163] offset:5120
    ds_write_b128 v177, v[164:167] offset:5136
    ds_write_b128 v177, v[168:171] offset:5632
    ds_write_b128 v177, v[172:175] offset:5648
    s_waitcnt lgkmcnt(0)
    s_barrier
    v_lshlrev_b32 v177, 2, v0
    ds_read_b32 v80, v177 offset:4096
    ds_read_b32 v81, v177 offset:6144
    ds_read_b32 v82, v177 offset:8192
    ds_read_b32 v83, v177 offset:10240
    ds_read_b32 v84, v177 offset:12288
    ds_read_b32 v85, v177 offset:14336
    ds_read_b32 v86, v177 offset:16384
    ds_read_b32 v87, v177 offset:18432
    ds_read_b32 v88, v177 offset:20480
    ds_read_b32 v89, v177 offset:22528
    ds_read_b32 v90, v177 offset:24576
    ds_read_b32 v91, v177 offset:26624
    ds_read_b32 v92, v177 offset:28672
    ds_read_b32 v93, v177 offset:30720
    ds_read_b32 v94, v177 offset:32768
    ds_read_b32 v95, v177 offset:34816
    ds_read_b32 v96, v177 offset:5120
    ds_read_b32 v97, v177 offset:7168
    ds_read_b32 v98, v177 offset:9216
    ds_read_b32 v99, v177 offset:11264
    ds_read_b32 v100, v177 offset:13312
    ds_read_b32 v101, v177 offset:15360
    ds_read_b32 v102, v177 offset:17408
    ds_read_b32 v103, v177 offset:19456
    ds_read_b32 v104, v177 offset:21504
    ds_read_b32 v105, v177 offset:23552
    ds_read_b32 v106, v177 offset:25600
    ds_read_b32 v107, v177 offset:27648
    ds_read_b32 v108, v177 offset:29696
    ds_read_b32 v109, v177 offset:31744
    ds_read_b32 v110, v177 offset:33792
    ds_read_b32 v111, v177 offset:35840
    s_waitcnt lgkmcnt(0)
    v_add_f32 v178, v80, v81
    v_add_f32 v178, v178, v82
    v_add_f32 v178, v178, v83
    v_add_f32 v178, v178, v84
    v_add_f32 v178, v178, v85
    v_add_f32 v178, v178, v86
    v_add_f32 v178, v178, v87
    v_add_f32 v178, v178, v88
    v_add_f32 v178, v178, v89
    v_add_f32 v178, v178, v90
    v_add_f32 v178, v178, v91
    v_add_f32 v178, v178, v92
    v_add_f32 v178, v178, v93
    v_add_f32 v178, v178, v94
    v_add_f32 v178, v178, v95
    v_add_f32 v179, v96, v97
    v_add_f32 v179, v179, v98
    v_add_f32 v179, v179, v99
    v_add_f32 v179, v179, v100
    v_add_f32 v179, v179, v101
    v_add_f32 v179, v179, v102
    v_add_f32 v179, v179, v103
    v_add_f32 v179, v179, v104
    v_add_f32 v179, v179, v105
    v_add_f32 v179, v179, v106
    v_add_f32 v179, v179, v107
    v_add_f32 v179, v179, v108
    v_add_f32 v179, v179, v109
    v_add_f32 v179, v179, v110
    v_add_f32 v179, v179, v111
    v_lshrrev_b32 v1, 7, v0
    v_lshlrev_b32 v1, 11, v1
    v_and_b32 v2, 127, v0
    v_lshlrev_b32 v2, 2, v2
    v_add_u32 v1, v1, v2
    s_lshl_b32 s22, s3, 17
    s_lshl_b32 s23, s20, 13
    s_add_u32 s22, s22, s23
    s_lshl_b32 s23, s21, 9
    s_add_u32 s22, s22, s23
    s_add_u32 s22, s22, 851968
    buffer_store_dword v178, v1, s[16:19], s22 offen
    s_add_u32 s22, s22, 4096
    buffer_store_dword v179, v1, s[16:19], s22 offen
K5_END:
    s_endpgm
.section .rodata,"a"
.p2align 6
.amdhsa_kernel k5_oproj_kernel
  .amdhsa_next_free_vgpr 180
  .amdhsa_next_free_sgpr 96
  .amdhsa_accum_offset 180
  .amdhsa_group_segment_fixed_size 0
  .amdhsa_kernarg_size 112
  .amdhsa_user_sgpr_count 2
  .amdhsa_user_sgpr_kernarg_segment_ptr 1
  .amdhsa_system_sgpr_workgroup_id_x 1
.end_amdhsa_kernel
.text
.globl concat_heads__sliding_block_cached__compressed_kv_cla__decode_kernel
.p2align 8
.type concat_heads__sliding_block_cached__compressed_kv_cla__decode_kernel,@function
concat_heads__sliding_block_cached__compressed_kv_cla__decode_kernel:
    s_cmp_ge_u32 s2, 16
    s_cbranch_scc1 K6_END
    s_load_dwordx2 s[4:5], s[0:1], 88
    s_load_dwordx2 s[6:7], s[0:1], 104
    s_waitcnt lgkmcnt(0)
    s_mov_b32 s8, s4
    s_mov_b32 s9, s5
    s_mov_b32 s10, 0x2000
    s_mov_b32 s11, 0x00020000
    s_mov_b32 s12, s6
    s_mov_b32 s13, s7
    s_mov_b32 s14, 0x10000000
    s_mov_b32 s15, 0x00020000
    s_lshl_b32 s3, s2, 8
    v_add_u32 v1, s3, v0
    v_lshrrev_b32 v2, 10, v1
    v_bfe_u32 v3, v1, 9, 1
    v_and_b32 v4, 511, v1
    v_lshlrev_b32 v2, 11, v2
    v_lshlrev_b32 v3, 17, v3
    v_lshlrev_b32 v4, 2, v4
    v_add_u32 v2, v2, v3
    v_add_u32 v2, v2, v4
    s_mov_b32 s16, 851968
    buffer_load_dword v8, v2, s[12:15], s16 offen
    s_add_u32 s16, s16, 8192
    buffer_load_dword v9, v2, s[12:15], s16 offen
    s_add_u32 s16, s16, 8192
    buffer_load_dword v10, v2, s[12:15], s16 offen
    s_add_u32 s16, s16, 8192
    buffer_load_dword v11, v2, s[12:15], s16 offen
    s_add_u32 s16, s16, 8192
    buffer_load_dword v12, v2, s[12:15], s16 offen
    s_add_u32 s16, s16, 8192
    buffer_load_dword v13, v2, s[12:15], s16 offen
    s_add_u32 s16, s16, 8192
    buffer_load_dword v14, v2, s[12:15], s16 offen
    s_add_u32 s16, s16, 8192
    buffer_load_dword v15, v2, s[12:15], s16 offen
    s_add_u32 s16, s16, 8192
    buffer_load_dword v16, v2, s[12:15], s16 offen
    s_add_u32 s16, s16, 8192
    buffer_load_dword v17, v2, s[12:15], s16 offen
    s_add_u32 s16, s16, 8192
    buffer_load_dword v18, v2, s[12:15], s16 offen
    s_add_u32 s16, s16, 8192
    buffer_load_dword v19, v2, s[12:15], s16 offen
    s_add_u32 s16, s16, 8192
    buffer_load_dword v20, v2, s[12:15], s16 offen
    s_add_u32 s16, s16, 8192
    buffer_load_dword v21, v2, s[12:15], s16 offen
    s_add_u32 s16, s16, 8192
    buffer_load_dword v22, v2, s[12:15], s16 offen
    s_add_u32 s16, s16, 8192
    buffer_load_dword v23, v2, s[12:15], s16 offen
    s_add_u32 s16, s16, 8192
    s_waitcnt vmcnt(0)
    v_add_f32 v5, v8, v9
    v_add_f32 v5, v5, v10
    v_add_f32 v5, v5, v11
    v_add_f32 v5, v5, v12
    v_add_f32 v5, v5, v13
    v_add_f32 v5, v5, v14
    v_add_f32 v5, v5, v15
    v_add_f32 v5, v5, v16
    v_add_f32 v5, v5, v17
    v_add_f32 v5, v5, v18
    v_add_f32 v5, v5, v19
    v_add_f32 v5, v5, v20
    v_add_f32 v5, v5, v21
    v_add_f32 v5, v5, v22
    v_add_f32 v5, v5, v23
    v_cvt_pk_bf16_f32 v5, v5, v5
    v_lshlrev_b32 v1, 1, v1
    buffer_store_short v5, v1, s[8:11], 0 offen
K6_END:
    s_endpgm
.section .rodata,"a"
.p2align 6
.amdhsa_kernel concat_heads__sliding_block_cached__compressed_kv_cla__decode_kernel
  .amdhsa_next_free_vgpr 32
  .amdhsa_next_free_sgpr 96
  .amdhsa_accum_offset 32
  .amdhsa_group_segment_fixed_size 0
  .amdhsa_kernarg_size 112
  .amdhsa_user_sgpr_count 2
  .amdhsa_user_sgpr_kernarg_segment_ptr 1
  .amdhsa_system_sgpr_workgroup_id_x 1
.end_amdhsa_kernel
```
